```python
import torch

def _softmax(x, axis=-1):
    return torch.softmax(x, dim=axis)
def _gelu(x):
    return torch.nn.functional.gelu(x, approximate="tanh")
def _silu(x):
    return torch.nn.functional.silu(x)
def _sigmoid(x):
    return torch.sigmoid(x)
def _layernorm(x, axis=-1, eps=1e-5):
    m = x.mean(dim=axis, keepdim=True)
    v = x.var(dim=axis, keepdim=True, unbiased=False)
    return (x - m) / torch.sqrt(v + eps)
def _scatter_add(tgt, idx, src, axis=0):
    return tgt.clone().index_add_(axis, idx, src)
def _segment_sum(src, seg, n):
    out = torch.zeros((n,) + src.shape[1:], dtype=src.dtype)
    return out.index_add_(0, seg, src)
def _pad(x, pw):
    flat = tuple(v for pair in reversed(pw) for v in pair)
    return torch.nn.functional.pad(x, flat)

kernel_name = 'gated_mix__softmax_full_mha__dense_activation_mish__prompt'

def setup_inputs():

    _w = (lambda a: (lambda t: t.to(torch.bfloat16) if t.is_floating_point() else t)(torch.as_tensor(a)))
    def _A_setup():
        B, S, D = 1, 2048, 512
        return {
            "x": _w((lambda *s: torch.randn(*s, dtype=torch.bfloat16) * 0.05)(B, S, D)),
            "wqkv": _w((lambda *s: torch.randn(*s, dtype=torch.bfloat16) * 0.8)(D, 3 * D)),
            "wo": _w((lambda *s: torch.randn(*s, dtype=torch.bfloat16) * 0.05)(D, D)),
        }
    _A_in = _A_setup()

    def _B_setup():
        B, S, D, F = 1, 2048, 512, 1376
        return {
            "x": _w((lambda *s: torch.randn(*s, dtype=torch.bfloat16) * 0.05)(B, S, D)),
            "w1": _w((lambda *s: torch.randn(*s, dtype=torch.bfloat16) * 12.8)(D, F) * (D ** -0.5)),
            "b1": _w((lambda *s: torch.randn(*s, dtype=torch.bfloat16) * 0.2)(F)),
            "w2": _w((lambda *s: torch.randn(*s, dtype=torch.bfloat16) * 0.1)(F, D) * (F ** -0.5)),
        }
    _B_in = _B_setup()

    return {
        "A_x": _A_in["x"],
        "A_wqkv": _A_in["wqkv"],
        "A_wo": _A_in["wo"],
        "B_x": _B_in["x"],
        "B_w1": _B_in["w1"],
        "B_b1": _B_in["b1"],
        "B_w2": _B_in["w2"],
        "gate_w": _w((lambda *s: torch.randn(*s, dtype=torch.bfloat16) * 0.05)(512) * 16.0),
    }

def reference(A_x, A_wqkv, A_wo, B_x, B_w1, B_b1, B_w2, gate_w):
    def _A_ref(x, wqkv, wo):
        B, S, D = x.shape
        H = 32; Dh = D // H
        qkv = (lambda x, *d: x.permute(*d))((x @ wqkv).reshape(B, S, 3, H, Dh), 2, 0, 3, 1, 4)
        q, k, v = qkv[0], qkv[1], qkv[2]
        scale = Dh ** -0.5
        scores = torch.einsum("bhqd,bhkd->bhqk", q, k) * scale
        p = _softmax(scores, axis=-1)
        o = torch.einsum("bhqk,bhkd->bhqd", p, v)
        return (lambda x, *d: x.permute(*d))(o, 0, 2, 1, 3).reshape(B, S, D) @ wo

    def _B_ref(x, w1, b1, w2):
        h = torch.einsum("bsd,df->bsf", x, w1) + b1
        sp = torch.log1p(torch.exp(-torch.abs(h))) + torch.where(h > 0, h, torch.zeros_like(h))
        act = h * torch.tanh(sp)
        return torch.einsum("bsf,fd->bsd", act, w2)

    x = A_x
    g = _sigmoid((x * gate_w).sum(-1, keepdims=True))
    a = _A_ref(x, A_wqkv, A_wo)
    b = _B_ref(x, B_w1, B_b1, B_w2)
    return g * a + (1 - g) * b
```

```asm
; @launch kernel=k1_proj_kernel grid=(256,1,1) block=(256,1,1) lds=143360
; @launch kernel=k2_attn_kernel grid=(256,1,1) block=(768,1,1) lds=155648
; @launch kernel=k3_out_kernel grid=(256,1,1) block=(512,1,1) lds=147456
.amdgcn_target "amdgcn-amd-amdhsa--gfx950"
.text
.globl k1_proj_kernel
.p2align 8
.type k1_proj_kernel,@function
k1_proj_kernel:
    s_cmp_ge_u32 s2, 256
    s_cbranch_scc1 K1_END
    s_load_dwordx4 s[4:7], s[0:1], 0
    s_load_dwordx2 s[12:13], s[0:1], 56
    s_load_dwordx2 s[14:15], s[0:1], 80
    v_and_b32 v1, 63, v0
    v_lshrrev_b32 v2, 6, v0
    s_nop 0
    v_readfirstlane_b32 s40, v2
    s_and_b32 s45, s2, 7
    s_lshr_b32 s46, s2, 3
    s_and_b32 s41, s45, 3
    s_lshl_b32 s41, s41, 2
    s_and_b32 s47, s46, 3
    s_add_u32 s41, s41, s47
    s_lshr_b32 s42, s45, 2
    s_lshl_b32 s42, s42, 3
    s_lshr_b32 s47, s46, 2
    s_add_u32 s42, s42, s47
    s_mul_i32 s51, s42, 96
    s_add_u32 s55, s41, s42
    s_lshl_b32 s45, s40, 5
    s_add_u32 s45, s45, 0
    v_lshrrev_b32 v2, 3, v1
    v_add_u32 v2, s45, v2
    v_lshrrev_b32 v3, 1, v2
    v_and_b32 v3, 7, v3
    v_and_b32 v4, 7, v1
    v_xor_b32 v3, v3, v4
    s_lshl_b32 s45, s41, 7
    v_add_u32 v2, s45, v2
    v_lshlrev_b32 v2, 10, v2
    v_lshl_add_u32 v8, v3, 4, v2
    s_lshl_b32 s45, s40, 5
    s_add_u32 s45, s45, 8
    v_lshrrev_b32 v2, 3, v1
    v_add_u32 v2, s45, v2
    v_lshrrev_b32 v3, 1, v2
    v_and_b32 v3, 7, v3
    v_and_b32 v4, 7, v1
    v_xor_b32 v3, v3, v4
    s_lshl_b32 s45, s41, 7
    v_add_u32 v2, s45, v2
    v_lshlrev_b32 v2, 10, v2
    v_lshl_add_u32 v9, v3, 4, v2
    s_lshl_b32 s45, s40, 5
    s_add_u32 s45, s45, 16
    v_lshrrev_b32 v2, 3, v1
    v_add_u32 v2, s45, v2
    v_lshrrev_b32 v3, 1, v2
    v_and_b32 v3, 7, v3
    v_and_b32 v4, 7, v1
    v_xor_b32 v3, v3, v4
    s_lshl_b32 s45, s41, 7
    v_add_u32 v2, s45, v2
    v_lshlrev_b32 v2, 10, v2
    v_lshl_add_u32 v10, v3, 4, v2
    s_lshl_b32 s45, s40, 5
    s_add_u32 s45, s45, 24
    v_lshrrev_b32 v2, 3, v1
    v_add_u32 v2, s45, v2
    v_lshrrev_b32 v3, 1, v2
    v_and_b32 v3, 7, v3
    v_and_b32 v4, 7, v1
    v_xor_b32 v3, v3, v4
    s_lshl_b32 s45, s41, 7
    v_add_u32 v2, s45, v2
    v_lshlrev_b32 v2, 10, v2
    v_lshl_add_u32 v11, v3, 4, v2
    s_mul_i32 s45, s40, 192
    s_add_u32 s45, s45, 0
    v_add_u32 v2, s45, v1
    v_mul_u32_u24 v3, 5462, v2
    v_lshrrev_b32 v3, 16, v3
    v_mul_u32_u24 v4, 12, v3
    v_sub_u32 v4, v2, v4
    v_mul_u32_u24 v3, 3072, v3
    v_lshl_add_u32 v3, v4, 4, v3
    s_lshl_b32 s45, s51, 1
    v_add_u32 v12, s45, v3
    s_mul_i32 s45, s40, 192
    s_add_u32 s45, s45, 64
    v_add_u32 v2, s45, v1
    v_mul_u32_u24 v3, 5462, v2
    v_lshrrev_b32 v3, 16, v3
    v_mul_u32_u24 v4, 12, v3
    v_sub_u32 v4, v2, v4
    v_mul_u32_u24 v3, 3072, v3
    v_lshl_add_u32 v3, v4, 4, v3
    s_lshl_b32 s45, s51, 1
    v_add_u32 v13, s45, v3
    s_mul_i32 s45, s40, 192
    s_add_u32 s45, s45, 128
    v_add_u32 v2, s45, v1
    v_mul_u32_u24 v3, 5462, v2
    v_lshrrev_b32 v3, 16, v3
    v_mul_u32_u24 v4, 12, v3
    v_sub_u32 v4, v2, v4
    v_mul_u32_u24 v3, 3072, v3
    v_lshl_add_u32 v3, v4, 4, v3
    s_lshl_b32 s45, s51, 1
    v_add_u32 v14, s45, v3
    s_lshl_b32 s48, s40, 12
    s_mul_i32 s49, s40, 3072
    s_add_u32 s49, s49, 16384
    s_lshl_b32 s45, s40, 5
    s_lshl_b32 s53, s41, 7
    s_add_u32 s53, s53, s45
    s_waitcnt lgkmcnt(0)
    s_mov_b32 s20, s4
    s_and_b32 s21, s5, 0xffff
    s_mov_b32 s22, 2097152
    s_mov_b32 s23, 0x00020000
    s_mov_b32 s24, s6
    s_and_b32 s25, s7, 0xffff
    s_mov_b32 s26, 1572864
    s_mov_b32 s27, 0x00020000
    s_mov_b32 s36, s12
    s_and_b32 s37, s13, 0xffff
    s_mov_b32 s38, 1024
    s_mov_b32 s39, 0x00020000
    s_lshl_b32 s45, s2, 3
    s_lshl_b32 s46, s40, 1
    s_add_u32 s45, s45, s46
    s_lshl_b32 s45, s45, 10
    v_lshlrev_b32 v2, 4, v1
    buffer_load_dwordx4 v[24:27], v2, s[20:23], s45 offen
    buffer_load_dwordx4 v[28:31], v2, s[20:23], s45 offen offset:1024
    buffer_load_dwordx4 v[32:35], v2, s[36:39], 0 offen
    s_add_u32 s45, s55, 0
    s_and_b32 s45, s45, 7
    s_lshl_b32 s45, s45, 7
    s_add_u32 m0, s48, 0
    s_nop 0
    buffer_load_dwordx4 v8, s[20:23], s45 offen lds
    s_add_u32 s45, s55, 0
    s_and_b32 s45, s45, 7
    s_lshl_b32 s45, s45, 7
    s_add_u32 m0, s48, 1024
    s_nop 0
    buffer_load_dwordx4 v9, s[20:23], s45 offen lds
    s_add_u32 s45, s55, 0
    s_and_b32 s45, s45, 7
    s_lshl_b32 s45, s45, 7
    s_add_u32 m0, s48, 2048
    s_nop 0
    buffer_load_dwordx4 v10, s[20:23], s45 offen lds
    s_add_u32 s45, s55, 0
    s_and_b32 s45, s45, 7
    s_lshl_b32 s45, s45, 7
    s_add_u32 m0, s48, 3072
    s_nop 0
    buffer_load_dwordx4 v11, s[20:23], s45 offen lds
    s_add_u32 s45, s55, 0
    s_and_b32 s45, s45, 7
    s_mul_i32 s45, s45, 196608
    s_add_u32 m0, s49, 0
    s_nop 0
    buffer_load_dwordx4 v12, s[24:27], s45 offen lds
    s_add_u32 s45, s55, 0
    s_and_b32 s45, s45, 7
    s_mul_i32 s45, s45, 196608
    s_add_u32 m0, s49, 1024
    s_nop 0
    buffer_load_dwordx4 v13, s[24:27], s45 offen lds
    s_add_u32 s45, s55, 0
    s_and_b32 s45, s45, 7
    s_mul_i32 s45, s45, 196608
    s_add_u32 m0, s49, 2048
    s_nop 0
    buffer_load_dwordx4 v14, s[24:27], s45 offen lds
    s_add_u32 s45, s55, 1
    s_and_b32 s45, s45, 7
    s_lshl_b32 s45, s45, 7
    s_add_u32 m0, s48, 28672
    s_nop 0
    buffer_load_dwordx4 v8, s[20:23], s45 offen lds
    s_add_u32 s45, s55, 1
    s_and_b32 s45, s45, 7
    s_lshl_b32 s45, s45, 7
    s_add_u32 m0, s48, 29696
    s_nop 0
    buffer_load_dwordx4 v9, s[20:23], s45 offen lds
    s_add_u32 s45, s55, 1
    s_and_b32 s45, s45, 7
    s_lshl_b32 s45, s45, 7
    s_add_u32 m0, s48, 30720
    s_nop 0
    buffer_load_dwordx4 v10, s[20:23], s45 offen lds
    s_add_u32 s45, s55, 1
    s_and_b32 s45, s45, 7
    s_lshl_b32 s45, s45, 7
    s_add_u32 m0, s48, 31744
    s_nop 0
    buffer_load_dwordx4 v11, s[20:23], s45 offen lds
    s_add_u32 s45, s55, 1
    s_and_b32 s45, s45, 7
    s_mul_i32 s45, s45, 196608
    s_add_u32 m0, s49, 28672
    s_nop 0
    buffer_load_dwordx4 v12, s[24:27], s45 offen lds
    s_add_u32 s45, s55, 1
    s_and_b32 s45, s45, 7
    s_mul_i32 s45, s45, 196608
    s_add_u32 m0, s49, 29696
    s_nop 0
    buffer_load_dwordx4 v13, s[24:27], s45 offen lds
    s_add_u32 s45, s55, 1
    s_and_b32 s45, s45, 7
    s_mul_i32 s45, s45, 196608
    s_add_u32 m0, s49, 30720
    s_nop 0
    buffer_load_dwordx4 v14, s[24:27], s45 offen lds
    s_mov_b32 s28, s14
    s_and_b32 s29, s15, 0xffff
    s_mov_b32 s30, 18874368
    s_mov_b32 s31, 0x00020000
    s_lshl_b32 s45, s40, 5
    v_and_b32 v2, 31, v1
    v_add_u32 v2, s45, v2
    v_lshrrev_b32 v3, 1, v2
    v_and_b32 v3, 7, v3
    v_lshrrev_b32 v4, 5, v1
    v_lshlrev_b32 v2, 7, v2
    v_add_u32 v5, 0, v4
    v_xor_b32 v5, v5, v3
    v_lshl_add_u32 v16, v5, 4, v2
    v_add_u32 v5, 2, v4
    v_xor_b32 v5, v5, v3
    v_lshl_add_u32 v17, v5, 4, v2
    v_add_u32 v5, 4, v4
    v_xor_b32 v5, v5, v3
    v_lshl_add_u32 v18, v5, 4, v2
    v_add_u32 v5, 6, v4
    v_xor_b32 v5, v5, v3
    v_lshl_add_u32 v19, v5, 4, v2
    v_lshrrev_b32 v2, 5, v1
    v_lshlrev_b32 v2, 3, v2
    v_bfe_u32 v3, v1, 2, 2
    v_add_u32 v2, v2, v3
    v_mul_u32_u24 v2, 192, v2
    v_and_b32 v4, 3, v1
    v_lshl_add_u32 v2, v4, 3, v2
    v_bfe_u32 v4, v1, 4, 1
    v_lshl_add_u32 v2, v4, 5, v2
    v_add_u32 v20, 16384, v2
    v_mov_b32 v80, 0
    v_mov_b32 v81, 0
    v_mov_b32 v82, 0
    v_mov_b32 v83, 0
    v_mov_b32 v84, 0
    v_mov_b32 v85, 0
    v_mov_b32 v86, 0
    v_mov_b32 v87, 0
    v_mov_b32 v88, 0
    v_mov_b32 v89, 0
    v_mov_b32 v90, 0
    v_mov_b32 v91, 0
    v_mov_b32 v92, 0
    v_mov_b32 v93, 0
    v_mov_b32 v94, 0
    v_mov_b32 v95, 0
    v_mov_b32 v96, 0
    v_mov_b32 v97, 0
    v_mov_b32 v98, 0
    v_mov_b32 v99, 0
    v_mov_b32 v100, 0
    v_mov_b32 v101, 0
    v_mov_b32 v102, 0
    v_mov_b32 v103, 0
    v_mov_b32 v104, 0
    v_mov_b32 v105, 0
    v_mov_b32 v106, 0
    v_mov_b32 v107, 0
    v_mov_b32 v108, 0
    v_mov_b32 v109, 0
    v_mov_b32 v110, 0
    v_mov_b32 v111, 0
    v_mov_b32 v112, 0
    v_mov_b32 v113, 0
    v_mov_b32 v114, 0
    v_mov_b32 v115, 0
    v_mov_b32 v116, 0
    v_mov_b32 v117, 0
    v_mov_b32 v118, 0
    v_mov_b32 v119, 0
    v_mov_b32 v120, 0
    v_mov_b32 v121, 0
    v_mov_b32 v122, 0
    v_mov_b32 v123, 0
    v_mov_b32 v124, 0
    v_mov_b32 v125, 0
    v_mov_b32 v126, 0
    v_mov_b32 v127, 0
    s_waitcnt vmcnt(14)
    v_lshlrev_b32 v36, 16, v24
    v_lshlrev_b32 v37, 16, v32
    v_and_b32 v38, 0xffff0000, v24
    v_and_b32 v39, 0xffff0000, v32
    v_mul_f32 v36, v36, v37
    v_mul_f32 v38, v38, v39
    v_cvt_pk_bf16_f32 v36, v36, v38
    v_lshlrev_b32 v37, 16, v36
    v_and_b32 v38, 0xffff0000, v36
    v_add_f32 v22, v37, v38
    v_lshlrev_b32 v36, 16, v25
    v_lshlrev_b32 v37, 16, v33
    v_and_b32 v38, 0xffff0000, v25
    v_and_b32 v39, 0xffff0000, v33
    v_mul_f32 v36, v36, v37
    v_mul_f32 v38, v38, v39
    v_cvt_pk_bf16_f32 v36, v36, v38
    v_lshlrev_b32 v37, 16, v36
    v_and_b32 v38, 0xffff0000, v36
    v_add_f32 v22, v22, v37
    v_add_f32 v22, v22, v38
    v_lshlrev_b32 v36, 16, v26
    v_lshlrev_b32 v37, 16, v34
    v_and_b32 v38, 0xffff0000, v26
    v_and_b32 v39, 0xffff0000, v34
    v_mul_f32 v36, v36, v37
    v_mul_f32 v38, v38, v39
    v_cvt_pk_bf16_f32 v36, v36, v38
    v_lshlrev_b32 v37, 16, v36
    v_and_b32 v38, 0xffff0000, v36
    v_add_f32 v22, v22, v37
    v_add_f32 v22, v22, v38
    v_lshlrev_b32 v36, 16, v27
    v_lshlrev_b32 v37, 16, v35
    v_and_b32 v38, 0xffff0000, v27
    v_and_b32 v39, 0xffff0000, v35
    v_mul_f32 v36, v36, v37
    v_mul_f32 v38, v38, v39
    v_cvt_pk_bf16_f32 v36, v36, v38
    v_lshlrev_b32 v37, 16, v36
    v_and_b32 v38, 0xffff0000, v36
    v_add_f32 v22, v22, v37
    v_add_f32 v22, v22, v38
    v_lshlrev_b32 v36, 16, v28
    v_lshlrev_b32 v37, 16, v32
    v_and_b32 v38, 0xffff0000, v28
    v_and_b32 v39, 0xffff0000, v32
    v_mul_f32 v36, v36, v37
    v_mul_f32 v38, v38, v39
    v_cvt_pk_bf16_f32 v36, v36, v38
    v_lshlrev_b32 v37, 16, v36
    v_and_b32 v38, 0xffff0000, v36
    v_add_f32 v23, v37, v38
    v_lshlrev_b32 v36, 16, v29
    v_lshlrev_b32 v37, 16, v33
    v_and_b32 v38, 0xffff0000, v29
    v_and_b32 v39, 0xffff0000, v33
    v_mul_f32 v36, v36, v37
    v_mul_f32 v38, v38, v39
    v_cvt_pk_bf16_f32 v36, v36, v38
    v_lshlrev_b32 v37, 16, v36
    v_and_b32 v38, 0xffff0000, v36
    v_add_f32 v23, v23, v37
    v_add_f32 v23, v23, v38
    v_lshlrev_b32 v36, 16, v30
    v_lshlrev_b32 v37, 16, v34
    v_and_b32 v38, 0xffff0000, v30
    v_and_b32 v39, 0xffff0000, v34
    v_mul_f32 v36, v36, v37
    v_mul_f32 v38, v38, v39
    v_cvt_pk_bf16_f32 v36, v36, v38
    v_lshlrev_b32 v37, 16, v36
    v_and_b32 v38, 0xffff0000, v36
    v_add_f32 v23, v23, v37
    v_add_f32 v23, v23, v38
    v_lshlrev_b32 v36, 16, v31
    v_lshlrev_b32 v37, 16, v35
    v_and_b32 v38, 0xffff0000, v31
    v_and_b32 v39, 0xffff0000, v35
    v_mul_f32 v36, v36, v37
    v_mul_f32 v38, v38, v39
    v_cvt_pk_bf16_f32 v36, v36, v38
    v_lshlrev_b32 v37, 16, v36
    v_and_b32 v38, 0xffff0000, v36
    v_add_f32 v23, v23, v37
    v_add_f32 v23, v23, v38
    v_xor_b32 v36, 1, v1
    v_lshlrev_b32 v36, 2, v36
    ds_bpermute_b32 v37, v36, v22
    ds_bpermute_b32 v38, v36, v23
    s_waitcnt lgkmcnt(0)
    v_add_f32 v22, v22, v37
    v_add_f32 v23, v23, v38
    v_xor_b32 v36, 2, v1
    v_lshlrev_b32 v36, 2, v36
    ds_bpermute_b32 v37, v36, v22
    ds_bpermute_b32 v38, v36, v23
    s_waitcnt lgkmcnt(0)
    v_add_f32 v22, v22, v37
    v_add_f32 v23, v23, v38
    v_xor_b32 v36, 4, v1
    v_lshlrev_b32 v36, 2, v36
    ds_bpermute_b32 v37, v36, v22
    ds_bpermute_b32 v38, v36, v23
    s_waitcnt lgkmcnt(0)
    v_add_f32 v22, v22, v37
    v_add_f32 v23, v23, v38
    v_xor_b32 v36, 8, v1
    v_lshlrev_b32 v36, 2, v36
    ds_bpermute_b32 v37, v36, v22
    ds_bpermute_b32 v38, v36, v23
    s_waitcnt lgkmcnt(0)
    v_add_f32 v22, v22, v37
    v_add_f32 v23, v23, v38
    v_xor_b32 v36, 16, v1
    v_lshlrev_b32 v36, 2, v36
    ds_bpermute_b32 v37, v36, v22
    ds_bpermute_b32 v38, v36, v23
    s_waitcnt lgkmcnt(0)
    v_add_f32 v22, v22, v37
    v_add_f32 v23, v23, v38
    v_xor_b32 v36, 32, v1
    v_lshlrev_b32 v36, 2, v36
    ds_bpermute_b32 v37, v36, v22
    ds_bpermute_b32 v38, v36, v23
    s_waitcnt lgkmcnt(0)
    v_add_f32 v22, v22, v37
    v_add_f32 v23, v23, v38
    v_cmp_eq_u32 vcc, 1, v1
    s_nop 1
    v_cndmask_b32 v22, v22, v23, vcc
    v_cvt_pk_bf16_f32 v22, v22, v22
    v_lshlrev_b32 v22, 16, v22
    v_mul_f32 v22, 0xbfb8aa3b, v22
    v_exp_f32 v22, v22
    s_nop 0
    v_add_f32 v22, 1.0, v22
    v_rcp_f32 v22, v22
    s_nop 0
    v_cvt_pk_bf16_f32 v22, v22, v22
    v_lshlrev_b32 v22, 16, v22
    s_cmp_ge_u32 s51, 1024
    s_cbranch_scc1 K1_NNN
    s_cmp_eq_u32 s51, 960
    s_cbranch_scc1 K1_TTN
    s_branch K1_TTT
K1_TTT:
    s_waitcnt vmcnt(7)
    s_barrier
    ds_read_b128 v[48:51], v16
    ds_read_b64_tr_b16 v[56:57], v20 offset:0
    ds_read_b64_tr_b16 v[58:59], v20 offset:768
    ds_read_b64_tr_b16 v[60:61], v20 offset:64
    ds_read_b64_tr_b16 v[62:63], v20 offset:832
    ds_read_b64_tr_b16 v[64:65], v20 offset:128
    ds_read_b64_tr_b16 v[66:67], v20 offset:896
    ds_read_b128 v[52:55], v17
    ds_read_b64_tr_b16 v[68:69], v20 offset:3072
    ds_read_b64_tr_b16 v[70:71], v20 offset:3840
    ds_read_b64_tr_b16 v[72:73], v20 offset:3136
    ds_read_b64_tr_b16 v[74:75], v20 offset:3904
    ds_read_b64_tr_b16 v[76:77], v20 offset:3200
    ds_read_b64_tr_b16 v[78:79], v20 offset:3968
    s_waitcnt lgkmcnt(7)
    v_mfma_f32_32x32x16_bf16 v[80:95], v[56:59], v[48:51], v[80:95]
    s_add_u32 s45, s55, 2
    s_and_b32 s45, s45, 7
    s_lshl_b32 s45, s45, 7
    s_add_u32 m0, s48, 57344
    s_nop 0
    buffer_load_dwordx4 v8, s[20:23], s45 offen lds
    v_mfma_f32_32x32x16_bf16 v[96:111], v[60:63], v[48:51], v[96:111]
    s_add_u32 s45, s55, 2
    s_and_b32 s45, s45, 7
    s_lshl_b32 s45, s45, 7
    s_add_u32 m0, s48, 58368
    s_nop 0
    buffer_load_dwordx4 v9, s[20:23], s45 offen lds
    v_mfma_f32_32x32x16_bf16 v[112:127], v[64:67], v[48:51], v[112:127]
    ds_read_b128 v[48:51], v18
    ds_read_b64_tr_b16 v[56:57], v20 offset:6144
    ds_read_b64_tr_b16 v[58:59], v20 offset:6912
    ds_read_b64_tr_b16 v[60:61], v20 offset:6208
    ds_read_b64_tr_b16 v[62:63], v20 offset:6976
    ds_read_b64_tr_b16 v[64:65], v20 offset:6272
    ds_read_b64_tr_b16 v[66:67], v20 offset:7040
    s_waitcnt lgkmcnt(7)
    v_mfma_f32_32x32x16_bf16 v[80:95], v[68:71], v[52:55], v[80:95]
    s_add_u32 s45, s55, 2
    s_and_b32 s45, s45, 7
    s_lshl_b32 s45, s45, 7
    s_add_u32 m0, s48, 59392
    s_nop 0
    buffer_load_dwordx4 v10, s[20:23], s45 offen lds
    v_mfma_f32_32x32x16_bf16 v[96:111], v[72:75], v[52:55], v[96:111]
    s_add_u32 s45, s55, 2
    s_and_b32 s45, s45, 7
    s_lshl_b32 s45, s45, 7
    s_add_u32 m0, s48, 60416
    s_nop 0
    buffer_load_dwordx4 v11, s[20:23], s45 offen lds
    v_mfma_f32_32x32x16_bf16 v[112:127], v[76:79], v[52:55], v[112:127]
    s_add_u32 s45, s55, 2
    s_and_b32 s45, s45, 7
    s_mul_i32 s45, s45, 196608
    s_add_u32 m0, s49, 57344
    s_nop 0
    buffer_load_dwordx4 v12, s[24:27], s45 offen lds
    s_add_u32 s45, s55, 2
    s_and_b32 s45, s45, 7
    s_mul_i32 s45, s45, 196608
    s_add_u32 m0, s49, 58368
    s_nop 0
    buffer_load_dwordx4 v13, s[24:27], s45 offen lds
    s_add_u32 s45, s55, 2
    s_and_b32 s45, s45, 7
    s_mul_i32 s45, s45, 196608
    s_add_u32 m0, s49, 59392
    s_nop 0
    buffer_load_dwordx4 v14, s[24:27], s45 offen lds
    s_add_u32 s45, s55, 3
    s_and_b32 s45, s45, 7
    s_lshl_b32 s45, s45, 7
    s_add_u32 m0, s48, 86016
    s_nop 0
    buffer_load_dwordx4 v8, s[20:23], s45 offen lds
    s_add_u32 s45, s55, 3
    s_and_b32 s45, s45, 7
    s_lshl_b32 s45, s45, 7
    s_add_u32 m0, s48, 87040
    s_nop 0
    buffer_load_dwordx4 v9, s[20:23], s45 offen lds
    s_add_u32 s45, s55, 3
    s_and_b32 s45, s45, 7
    s_lshl_b32 s45, s45, 7
    s_add_u32 m0, s48, 88064
    s_nop 0
    buffer_load_dwordx4 v10, s[20:23], s45 offen lds
    s_add_u32 s45, s55, 3
    s_and_b32 s45, s45, 7
    s_lshl_b32 s45, s45, 7
    s_add_u32 m0, s48, 89088
    s_nop 0
    buffer_load_dwordx4 v11, s[20:23], s45 offen lds
    s_add_u32 s45, s55, 3
    s_and_b32 s45, s45, 7
    s_mul_i32 s45, s45, 196608
    s_add_u32 m0, s49, 86016
    s_nop 0
    buffer_load_dwordx4 v12, s[24:27], s45 offen lds
    s_add_u32 s45, s55, 3
    s_and_b32 s45, s45, 7
    s_mul_i32 s45, s45, 196608
    s_add_u32 m0, s49, 87040
    s_nop 0
    buffer_load_dwordx4 v13, s[24:27], s45 offen lds
    s_add_u32 s45, s55, 3
    s_and_b32 s45, s45, 7
    s_mul_i32 s45, s45, 196608
    s_add_u32 m0, s49, 88064
    s_nop 0
    buffer_load_dwordx4 v14, s[24:27], s45 offen lds
    s_waitcnt vmcnt(14)
    s_barrier
    ds_read_b128 v[52:55], v19
    ds_read_b64_tr_b16 v[68:69], v20 offset:9216
    ds_read_b64_tr_b16 v[70:71], v20 offset:9984
    ds_read_b64_tr_b16 v[72:73], v20 offset:9280
    ds_read_b64_tr_b16 v[74:75], v20 offset:10048
    ds_read_b64_tr_b16 v[76:77], v20 offset:9344
    ds_read_b64_tr_b16 v[78:79], v20 offset:10112
    s_waitcnt lgkmcnt(7)
    v_mfma_f32_32x32x16_bf16 v[80:95], v[56:59], v[48:51], v[80:95]
    s_add_u32 s45, s55, 4
    s_and_b32 s45, s45, 7
    s_lshl_b32 s45, s45, 7
    s_add_u32 m0, s48, 114688
    s_nop 0
    buffer_load_dwordx4 v8, s[20:23], s45 offen lds
    v_mfma_f32_32x32x16_bf16 v[96:111], v[60:63], v[48:51], v[96:111]
    s_add_u32 s45, s55, 4
    s_and_b32 s45, s45, 7
    s_lshl_b32 s45, s45, 7
    s_add_u32 m0, s48, 115712
    s_nop 0
    buffer_load_dwordx4 v9, s[20:23], s45 offen lds
    v_mfma_f32_32x32x16_bf16 v[112:127], v[64:67], v[48:51], v[112:127]
    v_add_u32 v16, 28672, v16
    v_add_u32 v17, 28672, v17
    v_add_u32 v18, 28672, v18
    v_add_u32 v19, 28672, v19
    v_add_u32 v20, 28672, v20
    ds_read_b128 v[48:51], v16
    ds_read_b64_tr_b16 v[56:57], v20 offset:0
    ds_read_b64_tr_b16 v[58:59], v20 offset:768
    ds_read_b64_tr_b16 v[60:61], v20 offset:64
    ds_read_b64_tr_b16 v[62:63], v20 offset:832
    ds_read_b64_tr_b16 v[64:65], v20 offset:128
    ds_read_b64_tr_b16 v[66:67], v20 offset:896
    s_waitcnt lgkmcnt(7)
    v_mfma_f32_32x32x16_bf16 v[80:95], v[68:71], v[52:55], v[80:95]
    s_add_u32 s45, s55, 4
    s_and_b32 s45, s45, 7
    s_lshl_b32 s45, s45, 7
    s_add_u32 m0, s48, 116736
    s_nop 0
    buffer_load_dwordx4 v10, s[20:23], s45 offen lds
    v_mfma_f32_32x32x16_bf16 v[96:111], v[72:75], v[52:55], v[96:111]
    s_add_u32 s45, s55, 4
    s_and_b32 s45, s45, 7
    s_lshl_b32 s45, s45, 7
    s_add_u32 m0, s48, 117760
    s_nop 0
    buffer_load_dwordx4 v11, s[20:23], s45 offen lds
    v_mfma_f32_32x32x16_bf16 v[112:127], v[76:79], v[52:55], v[112:127]
    ds_read_b128 v[52:55], v17
    ds_read_b64_tr_b16 v[68:69], v20 offset:3072
    ds_read_b64_tr_b16 v[70:71], v20 offset:3840
    ds_read_b64_tr_b16 v[72:73], v20 offset:3136
    ds_read_b64_tr_b16 v[74:75], v20 offset:3904
    ds_read_b64_tr_b16 v[76:77], v20 offset:3200
    ds_read_b64_tr_b16 v[78:79], v20 offset:3968
    s_waitcnt lgkmcnt(7)
    v_mfma_f32_32x32x16_bf16 v[80:95], v[56:59], v[48:51], v[80:95]
    s_add_u32 s45, s55, 4
    s_and_b32 s45, s45, 7
    s_mul_i32 s45, s45, 196608
    s_add_u32 m0, s49, 114688
    s_nop 0
    buffer_load_dwordx4 v12, s[24:27], s45 offen lds
    v_mfma_f32_32x32x16_bf16 v[96:111], v[60:63], v[48:51], v[96:111]
    s_add_u32 s45, s55, 4
    s_and_b32 s45, s45, 7
    s_mul_i32 s45, s45, 196608
    s_add_u32 m0, s49, 115712
    s_nop 0
    buffer_load_dwordx4 v13, s[24:27], s45 offen lds
    v_mfma_f32_32x32x16_bf16 v[112:127], v[64:67], v[48:51], v[112:127]
    ds_read_b128 v[48:51], v18
    ds_read_b64_tr_b16 v[56:57], v20 offset:6144
    ds_read_b64_tr_b16 v[58:59], v20 offset:6912
    ds_read_b64_tr_b16 v[60:61], v20 offset:6208
    ds_read_b64_tr_b16 v[62:63], v20 offset:6976
    ds_read_b64_tr_b16 v[64:65], v20 offset:6272
    ds_read_b64_tr_b16 v[66:67], v20 offset:7040
    s_waitcnt lgkmcnt(7)
    v_mfma_f32_32x32x16_bf16 v[80:95], v[68:71], v[52:55], v[80:95]
    s_add_u32 s45, s55, 4
    s_and_b32 s45, s45, 7
    s_mul_i32 s45, s45, 196608
    s_add_u32 m0, s49, 116736
    s_nop 0
    buffer_load_dwordx4 v14, s[24:27], s45 offen lds
    v_mfma_f32_32x32x16_bf16 v[96:111], v[72:75], v[52:55], v[96:111]
    v_mfma_f32_32x32x16_bf16 v[112:127], v[76:79], v[52:55], v[112:127]
    s_waitcnt vmcnt(14)
    s_barrier
    ds_read_b128 v[52:55], v19
    ds_read_b64_tr_b16 v[68:69], v20 offset:9216
    ds_read_b64_tr_b16 v[70:71], v20 offset:9984
    ds_read_b64_tr_b16 v[72:73], v20 offset:9280
    ds_read_b64_tr_b16 v[74:75], v20 offset:10048
    ds_read_b64_tr_b16 v[76:77], v20 offset:9344
    ds_read_b64_tr_b16 v[78:79], v20 offset:10112
    s_waitcnt lgkmcnt(7)
    v_mfma_f32_32x32x16_bf16 v[80:95], v[56:59], v[48:51], v[80:95]
    s_add_u32 s45, s55, 5
    s_and_b32 s45, s45, 7
    s_lshl_b32 s45, s45, 7
    s_add_u32 m0, s48, 0
    s_nop 0
    buffer_load_dwordx4 v8, s[20:23], s45 offen lds
    v_mfma_f32_32x32x16_bf16 v[96:111], v[60:63], v[48:51], v[96:111]
    s_add_u32 s45, s55, 5
    s_and_b32 s45, s45, 7
    s_lshl_b32 s45, s45, 7
    s_add_u32 m0, s48, 1024
    s_nop 0
    buffer_load_dwordx4 v9, s[20:23], s45 offen lds
    v_mfma_f32_32x32x16_bf16 v[112:127], v[64:67], v[48:51], v[112:127]
    v_add_u32 v16, 28672, v16
    v_add_u32 v17, 28672, v17
    v_add_u32 v18, 28672, v18
    v_add_u32 v19, 28672, v19
    v_add_u32 v20, 28672, v20
    ds_read_b128 v[48:51], v16
    ds_read_b64_tr_b16 v[56:57], v20 offset:0
    ds_read_b64_tr_b16 v[58:59], v20 offset:768
    ds_read_b64_tr_b16 v[60:61], v20 offset:64
    ds_read_b64_tr_b16 v[62:63], v20 offset:832
    ds_read_b64_tr_b16 v[64:65], v20 offset:128
    ds_read_b64_tr_b16 v[66:67], v20 offset:896
    s_waitcnt lgkmcnt(7)
    v_mfma_f32_32x32x16_bf16 v[80:95], v[68:71], v[52:55], v[80:95]
    s_add_u32 s45, s55, 5
    s_and_b32 s45, s45, 7
    s_lshl_b32 s45, s45, 7
    s_add_u32 m0, s48, 2048
    s_nop 0
    buffer_load_dwordx4 v10, s[20:23], s45 offen lds
    v_mfma_f32_32x32x16_bf16 v[96:111], v[72:75], v[52:55], v[96:111]
    s_add_u32 s45, s55, 5
    s_and_b32 s45, s45, 7
    s_lshl_b32 s45, s45, 7
    s_add_u32 m0, s48, 3072
    s_nop 0
    buffer_load_dwordx4 v11, s[20:23], s45 offen lds
    v_mfma_f32_32x32x16_bf16 v[112:127], v[76:79], v[52:55], v[112:127]
    ds_read_b128 v[52:55], v17
    ds_read_b64_tr_b16 v[68:69], v20 offset:3072
    ds_read_b64_tr_b16 v[70:71], v20 offset:3840
    ds_read_b64_tr_b16 v[72:73], v20 offset:3136
    ds_read_b64_tr_b16 v[74:75], v20 offset:3904
    ds_read_b64_tr_b16 v[76:77], v20 offset:3200
    ds_read_b64_tr_b16 v[78:79], v20 offset:3968
    s_waitcnt lgkmcnt(7)
    v_mfma_f32_32x32x16_bf16 v[80:95], v[56:59], v[48:51], v[80:95]
    s_add_u32 s45, s55, 5
    s_and_b32 s45, s45, 7
    s_mul_i32 s45, s45, 196608
    s_add_u32 m0, s49, 0
    s_nop 0
    buffer_load_dwordx4 v12, s[24:27], s45 offen lds
    v_mfma_f32_32x32x16_bf16 v[96:111], v[60:63], v[48:51], v[96:111]
    s_add_u32 s45, s55, 5
    s_and_b32 s45, s45, 7
    s_mul_i32 s45, s45, 196608
    s_add_u32 m0, s49, 1024
    s_nop 0
    buffer_load_dwordx4 v13, s[24:27], s45 offen lds
    v_mfma_f32_32x32x16_bf16 v[112:127], v[64:67], v[48:51], v[112:127]
    ds_read_b128 v[48:51], v18
    ds_read_b64_tr_b16 v[56:57], v20 offset:6144
    ds_read_b64_tr_b16 v[58:59], v20 offset:6912
    ds_read_b64_tr_b16 v[60:61], v20 offset:6208
    ds_read_b64_tr_b16 v[62:63], v20 offset:6976
    ds_read_b64_tr_b16 v[64:65], v20 offset:6272
    ds_read_b64_tr_b16 v[66:67], v20 offset:7040
    s_waitcnt lgkmcnt(7)
    v_mfma_f32_32x32x16_bf16 v[80:95], v[68:71], v[52:55], v[80:95]
    s_add_u32 s45, s55, 5
    s_and_b32 s45, s45, 7
    s_mul_i32 s45, s45, 196608
    s_add_u32 m0, s49, 2048
    s_nop 0
    buffer_load_dwordx4 v14, s[24:27], s45 offen lds
    v_mfma_f32_32x32x16_bf16 v[96:111], v[72:75], v[52:55], v[96:111]
    v_mfma_f32_32x32x16_bf16 v[112:127], v[76:79], v[52:55], v[112:127]
    s_waitcnt vmcnt(14)
    s_barrier
    ds_read_b128 v[52:55], v19
    ds_read_b64_tr_b16 v[68:69], v20 offset:9216
    ds_read_b64_tr_b16 v[70:71], v20 offset:9984
    ds_read_b64_tr_b16 v[72:73], v20 offset:9280
    ds_read_b64_tr_b16 v[74:75], v20 offset:10048
    ds_read_b64_tr_b16 v[76:77], v20 offset:9344
    ds_read_b64_tr_b16 v[78:79], v20 offset:10112
    s_waitcnt lgkmcnt(7)
    v_mfma_f32_32x32x16_bf16 v[80:95], v[56:59], v[48:51], v[80:95]
    s_add_u32 s45, s55, 6
    s_and_b32 s45, s45, 7
    s_lshl_b32 s45, s45, 7
    s_add_u32 m0, s48, 28672
    s_nop 0
    buffer_load_dwordx4 v8, s[20:23], s45 offen lds
    v_mfma_f32_32x32x16_bf16 v[96:111], v[60:63], v[48:51], v[96:111]
    s_add_u32 s45, s55, 6
    s_and_b32 s45, s45, 7
    s_lshl_b32 s45, s45, 7
    s_add_u32 m0, s48, 29696
    s_nop 0
    buffer_load_dwordx4 v9, s[20:23], s45 offen lds
    v_mfma_f32_32x32x16_bf16 v[112:127], v[64:67], v[48:51], v[112:127]
    v_add_u32 v16, 28672, v16
    v_add_u32 v17, 28672, v17
    v_add_u32 v18, 28672, v18
    v_add_u32 v19, 28672, v19
    v_add_u32 v20, 28672, v20
    ds_read_b128 v[48:51], v16
    ds_read_b64_tr_b16 v[56:57], v20 offset:0
    ds_read_b64_tr_b16 v[58:59], v20 offset:768
    ds_read_b64_tr_b16 v[60:61], v20 offset:64
    ds_read_b64_tr_b16 v[62:63], v20 offset:832
    ds_read_b64_tr_b16 v[64:65], v20 offset:128
    ds_read_b64_tr_b16 v[66:67], v20 offset:896
    s_waitcnt lgkmcnt(7)
    v_mfma_f32_32x32x16_bf16 v[80:95], v[68:71], v[52:55], v[80:95]
    s_add_u32 s45, s55, 6
    s_and_b32 s45, s45, 7
    s_lshl_b32 s45, s45, 7
    s_add_u32 m0, s48, 30720
    s_nop 0
    buffer_load_dwordx4 v10, s[20:23], s45 offen lds
    v_mfma_f32_32x32x16_bf16 v[96:111], v[72:75], v[52:55], v[96:111]
    s_add_u32 s45, s55, 6
    s_and_b32 s45, s45, 7
    s_lshl_b32 s45, s45, 7
    s_add_u32 m0, s48, 31744
    s_nop 0
    buffer_load_dwordx4 v11, s[20:23], s45 offen lds
    v_mfma_f32_32x32x16_bf16 v[112:127], v[76:79], v[52:55], v[112:127]
    ds_read_b128 v[52:55], v17
    ds_read_b64_tr_b16 v[68:69], v20 offset:3072
    ds_read_b64_tr_b16 v[70:71], v20 offset:3840
    ds_read_b64_tr_b16 v[72:73], v20 offset:3136
    ds_read_b64_tr_b16 v[74:75], v20 offset:3904
    ds_read_b64_tr_b16 v[76:77], v20 offset:3200
    ds_read_b64_tr_b16 v[78:79], v20 offset:3968
    s_waitcnt lgkmcnt(7)
    v_mfma_f32_32x32x16_bf16 v[80:95], v[56:59], v[48:51], v[80:95]
    s_add_u32 s45, s55, 6
    s_and_b32 s45, s45, 7
    s_mul_i32 s45, s45, 196608
    s_add_u32 m0, s49, 28672
    s_nop 0
    buffer_load_dwordx4 v12, s[24:27], s45 offen lds
    v_mfma_f32_32x32x16_bf16 v[96:111], v[60:63], v[48:51], v[96:111]
    s_add_u32 s45, s55, 6
    s_and_b32 s45, s45, 7
    s_mul_i32 s45, s45, 196608
    s_add_u32 m0, s49, 29696
    s_nop 0
    buffer_load_dwordx4 v13, s[24:27], s45 offen lds
    v_mfma_f32_32x32x16_bf16 v[112:127], v[64:67], v[48:51], v[112:127]
    ds_read_b128 v[48:51], v18
    ds_read_b64_tr_b16 v[56:57], v20 offset:6144
    ds_read_b64_tr_b16 v[58:59], v20 offset:6912
    ds_read_b64_tr_b16 v[60:61], v20 offset:6208
    ds_read_b64_tr_b16 v[62:63], v20 offset:6976
    ds_read_b64_tr_b16 v[64:65], v20 offset:6272
    ds_read_b64_tr_b16 v[66:67], v20 offset:7040
    s_waitcnt lgkmcnt(7)
    v_mfma_f32_32x32x16_bf16 v[80:95], v[68:71], v[52:55], v[80:95]
    s_add_u32 s45, s55, 6
    s_and_b32 s45, s45, 7
    s_mul_i32 s45, s45, 196608
    s_add_u32 m0, s49, 30720
    s_nop 0
    buffer_load_dwordx4 v14, s[24:27], s45 offen lds
    v_mfma_f32_32x32x16_bf16 v[96:111], v[72:75], v[52:55], v[96:111]
    v_mfma_f32_32x32x16_bf16 v[112:127], v[76:79], v[52:55], v[112:127]
    s_waitcnt vmcnt(14)
    s_barrier
    ds_read_b128 v[52:55], v19
    ds_read_b64_tr_b16 v[68:69], v20 offset:9216
    ds_read_b64_tr_b16 v[70:71], v20 offset:9984
    ds_read_b64_tr_b16 v[72:73], v20 offset:9280
    ds_read_b64_tr_b16 v[74:75], v20 offset:10048
    ds_read_b64_tr_b16 v[76:77], v20 offset:9344
    ds_read_b64_tr_b16 v[78:79], v20 offset:10112
    s_waitcnt lgkmcnt(7)
    v_mfma_f32_32x32x16_bf16 v[80:95], v[56:59], v[48:51], v[80:95]
    s_add_u32 s45, s55, 7
    s_and_b32 s45, s45, 7
    s_lshl_b32 s45, s45, 7
    s_add_u32 m0, s48, 57344
    s_nop 0
    buffer_load_dwordx4 v8, s[20:23], s45 offen lds
    v_mfma_f32_32x32x16_bf16 v[96:111], v[60:63], v[48:51], v[96:111]
    s_add_u32 s45, s55, 7
    s_and_b32 s45, s45, 7
    s_lshl_b32 s45, s45, 7
    s_add_u32 m0, s48, 58368
    s_nop 0
    buffer_load_dwordx4 v9, s[20:23], s45 offen lds
    v_mfma_f32_32x32x16_bf16 v[112:127], v[64:67], v[48:51], v[112:127]
    v_add_u32 v16, 28672, v16
    v_add_u32 v17, 28672, v17
    v_add_u32 v18, 28672, v18
    v_add_u32 v19, 28672, v19
    v_add_u32 v20, 28672, v20
    ds_read_b128 v[48:51], v16
    ds_read_b64_tr_b16 v[56:57], v20 offset:0
    ds_read_b64_tr_b16 v[58:59], v20 offset:768
    ds_read_b64_tr_b16 v[60:61], v20 offset:64
    ds_read_b64_tr_b16 v[62:63], v20 offset:832
    ds_read_b64_tr_b16 v[64:65], v20 offset:128
    ds_read_b64_tr_b16 v[66:67], v20 offset:896
    s_waitcnt lgkmcnt(7)
    v_mfma_f32_32x32x16_bf16 v[80:95], v[68:71], v[52:55], v[80:95]
    s_add_u32 s45, s55, 7
    s_and_b32 s45, s45, 7
    s_lshl_b32 s45, s45, 7
    s_add_u32 m0, s48, 59392
    s_nop 0
    buffer_load_dwordx4 v10, s[20:23], s45 offen lds
    v_mfma_f32_32x32x16_bf16 v[96:111], v[72:75], v[52:55], v[96:111]
    s_add_u32 s45, s55, 7
    s_and_b32 s45, s45, 7
    s_lshl_b32 s45, s45, 7
    s_add_u32 m0, s48, 60416
    s_nop 0
    buffer_load_dwordx4 v11, s[20:23], s45 offen lds
    v_mfma_f32_32x32x16_bf16 v[112:127], v[76:79], v[52:55], v[112:127]
    ds_read_b128 v[52:55], v17
    ds_read_b64_tr_b16 v[68:69], v20 offset:3072
    ds_read_b64_tr_b16 v[70:71], v20 offset:3840
    ds_read_b64_tr_b16 v[72:73], v20 offset:3136
    ds_read_b64_tr_b16 v[74:75], v20 offset:3904
    ds_read_b64_tr_b16 v[76:77], v20 offset:3200
    ds_read_b64_tr_b16 v[78:79], v20 offset:3968
    s_waitcnt lgkmcnt(7)
    v_mfma_f32_32x32x16_bf16 v[80:95], v[56:59], v[48:51], v[80:95]
    s_add_u32 s45, s55, 7
    s_and_b32 s45, s45, 7
    s_mul_i32 s45, s45, 196608
    s_add_u32 m0, s49, 57344
    s_nop 0
    buffer_load_dwordx4 v12, s[24:27], s45 offen lds
    v_mfma_f32_32x32x16_bf16 v[96:111], v[60:63], v[48:51], v[96:111]
    s_add_u32 s45, s55, 7
    s_and_b32 s45, s45, 7
    s_mul_i32 s45, s45, 196608
    s_add_u32 m0, s49, 58368
    s_nop 0
    buffer_load_dwordx4 v13, s[24:27], s45 offen lds
    v_mfma_f32_32x32x16_bf16 v[112:127], v[64:67], v[48:51], v[112:127]
    ds_read_b128 v[48:51], v18
    ds_read_b64_tr_b16 v[56:57], v20 offset:6144
    ds_read_b64_tr_b16 v[58:59], v20 offset:6912
    ds_read_b64_tr_b16 v[60:61], v20 offset:6208
    ds_read_b64_tr_b16 v[62:63], v20 offset:6976
    ds_read_b64_tr_b16 v[64:65], v20 offset:6272
    ds_read_b64_tr_b16 v[66:67], v20 offset:7040
    s_waitcnt lgkmcnt(7)
    v_mfma_f32_32x32x16_bf16 v[80:95], v[68:71], v[52:55], v[80:95]
    s_add_u32 s45, s55, 7
    s_and_b32 s45, s45, 7
    s_mul_i32 s45, s45, 196608
    s_add_u32 m0, s49, 59392
    s_nop 0
    buffer_load_dwordx4 v14, s[24:27], s45 offen lds
    v_mfma_f32_32x32x16_bf16 v[96:111], v[72:75], v[52:55], v[96:111]
    v_mfma_f32_32x32x16_bf16 v[112:127], v[76:79], v[52:55], v[112:127]
    s_waitcnt vmcnt(14)
    s_barrier
    ds_read_b128 v[52:55], v19
    ds_read_b64_tr_b16 v[68:69], v20 offset:9216
    ds_read_b64_tr_b16 v[70:71], v20 offset:9984
    ds_read_b64_tr_b16 v[72:73], v20 offset:9280
    ds_read_b64_tr_b16 v[74:75], v20 offset:10048
    ds_read_b64_tr_b16 v[76:77], v20 offset:9344
    ds_read_b64_tr_b16 v[78:79], v20 offset:10112
    s_waitcnt lgkmcnt(7)
    v_mfma_f32_32x32x16_bf16 v[80:95], v[56:59], v[48:51], v[80:95]
    v_mfma_f32_32x32x16_bf16 v[96:111], v[60:63], v[48:51], v[96:111]
    v_mfma_f32_32x32x16_bf16 v[112:127], v[64:67], v[48:51], v[112:127]
    v_subrev_u32 v16, 114688, v16
    v_subrev_u32 v17, 114688, v17
    v_subrev_u32 v18, 114688, v18
    v_subrev_u32 v19, 114688, v19
    v_subrev_u32 v20, 114688, v20
    ds_read_b128 v[48:51], v16
    ds_read_b64_tr_b16 v[56:57], v20 offset:0
    ds_read_b64_tr_b16 v[58:59], v20 offset:768
    ds_read_b64_tr_b16 v[60:61], v20 offset:64
    ds_read_b64_tr_b16 v[62:63], v20 offset:832
    ds_read_b64_tr_b16 v[64:65], v20 offset:128
    ds_read_b64_tr_b16 v[66:67], v20 offset:896
    s_waitcnt lgkmcnt(7)
    v_mfma_f32_32x32x16_bf16 v[80:95], v[68:71], v[52:55], v[80:95]
    v_mfma_f32_32x32x16_bf16 v[96:111], v[72:75], v[52:55], v[96:111]
    v_mfma_f32_32x32x16_bf16 v[112:127], v[76:79], v[52:55], v[112:127]
    ds_read_b128 v[52:55], v17
    ds_read_b64_tr_b16 v[68:69], v20 offset:3072
    ds_read_b64_tr_b16 v[70:71], v20 offset:3840
    ds_read_b64_tr_b16 v[72:73], v20 offset:3136
    ds_read_b64_tr_b16 v[74:75], v20 offset:3904
    ds_read_b64_tr_b16 v[76:77], v20 offset:3200
    ds_read_b64_tr_b16 v[78:79], v20 offset:3968
    s_waitcnt lgkmcnt(7)
    v_mfma_f32_32x32x16_bf16 v[80:95], v[56:59], v[48:51], v[80:95]
    v_mfma_f32_32x32x16_bf16 v[96:111], v[60:63], v[48:51], v[96:111]
    v_mfma_f32_32x32x16_bf16 v[112:127], v[64:67], v[48:51], v[112:127]
    ds_read_b128 v[48:51], v18
    ds_read_b64_tr_b16 v[56:57], v20 offset:6144
    ds_read_b64_tr_b16 v[58:59], v20 offset:6912
    ds_read_b64_tr_b16 v[60:61], v20 offset:6208
    ds_read_b64_tr_b16 v[62:63], v20 offset:6976
    ds_read_b64_tr_b16 v[64:65], v20 offset:6272
    ds_read_b64_tr_b16 v[66:67], v20 offset:7040
    s_waitcnt lgkmcnt(7)
    v_mfma_f32_32x32x16_bf16 v[80:95], v[68:71], v[52:55], v[80:95]
    v_mfma_f32_32x32x16_bf16 v[96:111], v[72:75], v[52:55], v[96:111]
    v_mfma_f32_32x32x16_bf16 v[112:127], v[76:79], v[52:55], v[112:127]
    s_waitcnt vmcnt(7)
    s_barrier
    ds_read_b128 v[52:55], v19
    ds_read_b64_tr_b16 v[68:69], v20 offset:9216
    ds_read_b64_tr_b16 v[70:71], v20 offset:9984
    ds_read_b64_tr_b16 v[72:73], v20 offset:9280
    ds_read_b64_tr_b16 v[74:75], v20 offset:10048
    ds_read_b64_tr_b16 v[76:77], v20 offset:9344
    ds_read_b64_tr_b16 v[78:79], v20 offset:10112
    s_waitcnt lgkmcnt(7)
    v_mfma_f32_32x32x16_bf16 v[80:95], v[56:59], v[48:51], v[80:95]
    v_mfma_f32_32x32x16_bf16 v[96:111], v[60:63], v[48:51], v[96:111]
    v_mfma_f32_32x32x16_bf16 v[112:127], v[64:67], v[48:51], v[112:127]
    v_add_u32 v16, 28672, v16
    v_add_u32 v17, 28672, v17
    v_add_u32 v18, 28672, v18
    v_add_u32 v19, 28672, v19
    v_add_u32 v20, 28672, v20
    ds_read_b128 v[48:51], v16
    ds_read_b64_tr_b16 v[56:57], v20 offset:0
    ds_read_b64_tr_b16 v[58:59], v20 offset:768
    ds_read_b64_tr_b16 v[60:61], v20 offset:64
    ds_read_b64_tr_b16 v[62:63], v20 offset:832
    ds_read_b64_tr_b16 v[64:65], v20 offset:128
    ds_read_b64_tr_b16 v[66:67], v20 offset:896
    s_waitcnt lgkmcnt(7)
    v_mfma_f32_32x32x16_bf16 v[80:95], v[68:71], v[52:55], v[80:95]
    v_mfma_f32_32x32x16_bf16 v[96:111], v[72:75], v[52:55], v[96:111]
    v_mfma_f32_32x32x16_bf16 v[112:127], v[76:79], v[52:55], v[112:127]
    ds_read_b128 v[52:55], v17
    ds_read_b64_tr_b16 v[68:69], v20 offset:3072
    ds_read_b64_tr_b16 v[70:71], v20 offset:3840
    ds_read_b64_tr_b16 v[72:73], v20 offset:3136
    ds_read_b64_tr_b16 v[74:75], v20 offset:3904
    ds_read_b64_tr_b16 v[76:77], v20 offset:3200
    ds_read_b64_tr_b16 v[78:79], v20 offset:3968
    s_waitcnt lgkmcnt(7)
    v_mfma_f32_32x32x16_bf16 v[80:95], v[56:59], v[48:51], v[80:95]
    v_mfma_f32_32x32x16_bf16 v[96:111], v[60:63], v[48:51], v[96:111]
    v_mfma_f32_32x32x16_bf16 v[112:127], v[64:67], v[48:51], v[112:127]
    ds_read_b128 v[48:51], v18
    ds_read_b64_tr_b16 v[56:57], v20 offset:6144
    ds_read_b64_tr_b16 v[58:59], v20 offset:6912
    ds_read_b64_tr_b16 v[60:61], v20 offset:6208
    ds_read_b64_tr_b16 v[62:63], v20 offset:6976
    ds_read_b64_tr_b16 v[64:65], v20 offset:6272
    ds_read_b64_tr_b16 v[66:67], v20 offset:7040
    s_waitcnt lgkmcnt(7)
    v_mfma_f32_32x32x16_bf16 v[80:95], v[68:71], v[52:55], v[80:95]
    v_mfma_f32_32x32x16_bf16 v[96:111], v[72:75], v[52:55], v[96:111]
    v_mfma_f32_32x32x16_bf16 v[112:127], v[76:79], v[52:55], v[112:127]
    s_waitcnt vmcnt(0)
    s_barrier
    ds_read_b128 v[52:55], v19
    ds_read_b64_tr_b16 v[68:69], v20 offset:9216
    ds_read_b64_tr_b16 v[70:71], v20 offset:9984
    ds_read_b64_tr_b16 v[72:73], v20 offset:9280
    ds_read_b64_tr_b16 v[74:75], v20 offset:10048
    ds_read_b64_tr_b16 v[76:77], v20 offset:9344
    ds_read_b64_tr_b16 v[78:79], v20 offset:10112
    s_waitcnt lgkmcnt(7)
    v_mfma_f32_32x32x16_bf16 v[80:95], v[56:59], v[48:51], v[80:95]
    v_mfma_f32_32x32x16_bf16 v[96:111], v[60:63], v[48:51], v[96:111]
    v_mfma_f32_32x32x16_bf16 v[112:127], v[64:67], v[48:51], v[112:127]
    v_add_u32 v16, 28672, v16
    v_add_u32 v17, 28672, v17
    v_add_u32 v18, 28672, v18
    v_add_u32 v19, 28672, v19
    v_add_u32 v20, 28672, v20
    ds_read_b128 v[48:51], v16
    ds_read_b64_tr_b16 v[56:57], v20 offset:0
    ds_read_b64_tr_b16 v[58:59], v20 offset:768
    ds_read_b64_tr_b16 v[60:61], v20 offset:64
    ds_read_b64_tr_b16 v[62:63], v20 offset:832
    ds_read_b64_tr_b16 v[64:65], v20 offset:128
    ds_read_b64_tr_b16 v[66:67], v20 offset:896
    s_waitcnt lgkmcnt(7)
    v_mfma_f32_32x32x16_bf16 v[80:95], v[68:71], v[52:55], v[80:95]
    v_mfma_f32_32x32x16_bf16 v[96:111], v[72:75], v[52:55], v[96:111]
    v_mfma_f32_32x32x16_bf16 v[112:127], v[76:79], v[52:55], v[112:127]
    ds_read_b128 v[52:55], v17
    ds_read_b64_tr_b16 v[68:69], v20 offset:3072
    ds_read_b64_tr_b16 v[70:71], v20 offset:3840
    ds_read_b64_tr_b16 v[72:73], v20 offset:3136
    ds_read_b64_tr_b16 v[74:75], v20 offset:3904
    ds_read_b64_tr_b16 v[76:77], v20 offset:3200
    ds_read_b64_tr_b16 v[78:79], v20 offset:3968
    s_waitcnt lgkmcnt(7)
    v_mfma_f32_32x32x16_bf16 v[80:95], v[56:59], v[48:51], v[80:95]
    v_mfma_f32_32x32x16_bf16 v[96:111], v[60:63], v[48:51], v[96:111]
    v_mfma_f32_32x32x16_bf16 v[112:127], v[64:67], v[48:51], v[112:127]
    ds_read_b128 v[48:51], v18
    ds_read_b64_tr_b16 v[56:57], v20 offset:6144
    ds_read_b64_tr_b16 v[58:59], v20 offset:6912
    ds_read_b64_tr_b16 v[60:61], v20 offset:6208
    ds_read_b64_tr_b16 v[62:63], v20 offset:6976
    ds_read_b64_tr_b16 v[64:65], v20 offset:6272
    ds_read_b64_tr_b16 v[66:67], v20 offset:7040
    s_waitcnt lgkmcnt(7)
    v_mfma_f32_32x32x16_bf16 v[80:95], v[68:71], v[52:55], v[80:95]
    v_mfma_f32_32x32x16_bf16 v[96:111], v[72:75], v[52:55], v[96:111]
    v_mfma_f32_32x32x16_bf16 v[112:127], v[76:79], v[52:55], v[112:127]
    ds_read_b128 v[52:55], v19
    ds_read_b64_tr_b16 v[68:69], v20 offset:9216
    ds_read_b64_tr_b16 v[70:71], v20 offset:9984
    ds_read_b64_tr_b16 v[72:73], v20 offset:9280
    ds_read_b64_tr_b16 v[74:75], v20 offset:10048
    ds_read_b64_tr_b16 v[76:77], v20 offset:9344
    ds_read_b64_tr_b16 v[78:79], v20 offset:10112
    s_waitcnt lgkmcnt(7)
    v_mfma_f32_32x32x16_bf16 v[80:95], v[56:59], v[48:51], v[80:95]
    v_mfma_f32_32x32x16_bf16 v[96:111], v[60:63], v[48:51], v[96:111]
    v_mfma_f32_32x32x16_bf16 v[112:127], v[64:67], v[48:51], v[112:127]
    s_waitcnt lgkmcnt(0)
    v_mfma_f32_32x32x16_bf16 v[80:95], v[68:71], v[52:55], v[80:95]
    v_mfma_f32_32x32x16_bf16 v[96:111], v[72:75], v[52:55], v[96:111]
    v_mfma_f32_32x32x16_bf16 v[112:127], v[76:79], v[52:55], v[112:127]
    s_branch K1_EPI
K1_TTN:
    s_waitcnt vmcnt(7)
    s_barrier
    ds_read_b128 v[48:51], v16
    ds_read_b64_tr_b16 v[56:57], v20 offset:0
    ds_read_b64_tr_b16 v[58:59], v20 offset:768
    ds_read_b64_tr_b16 v[60:61], v20 offset:64
    ds_read_b64_tr_b16 v[62:63], v20 offset:832
    ds_read_b64_tr_b16 v[64:65], v20 offset:128
    ds_read_b64_tr_b16 v[66:67], v20 offset:896
    ds_read_b128 v[52:55], v17
    ds_read_b64_tr_b16 v[68:69], v20 offset:3072
    ds_read_b64_tr_b16 v[70:71], v20 offset:3840
    ds_read_b64_tr_b16 v[72:73], v20 offset:3136
    ds_read_b64_tr_b16 v[74:75], v20 offset:3904
    ds_read_b64_tr_b16 v[76:77], v20 offset:3200
    ds_read_b64_tr_b16 v[78:79], v20 offset:3968
    s_waitcnt lgkmcnt(7)
    v_mfma_f32_32x32x16_bf16 v[80:95], v[56:59], v[48:51], v[80:95]
    s_add_u32 s45, s55, 2
    s_and_b32 s45, s45, 7
    s_lshl_b32 s45, s45, 7
    s_add_u32 m0, s48, 57344
    s_nop 0
    buffer_load_dwordx4 v8, s[20:23], s45 offen lds
    v_mfma_f32_32x32x16_bf16 v[96:111], v[60:63], v[48:51], v[96:111]
    s_add_u32 s45, s55, 2
    s_and_b32 s45, s45, 7
    s_lshl_b32 s45, s45, 7
    s_add_u32 m0, s48, 58368
    s_nop 0
    buffer_load_dwordx4 v9, s[20:23], s45 offen lds
    v_mfma_f32_32x32x16_bf16 v[112:127], v[48:51], v[64:67], v[112:127]
    ds_read_b128 v[48:51], v18
    ds_read_b64_tr_b16 v[56:57], v20 offset:6144
    ds_read_b64_tr_b16 v[58:59], v20 offset:6912
    ds_read_b64_tr_b16 v[60:61], v20 offset:6208
    ds_read_b64_tr_b16 v[62:63], v20 offset:6976
    ds_read_b64_tr_b16 v[64:65], v20 offset:6272
    ds_read_b64_tr_b16 v[66:67], v20 offset:7040
    s_waitcnt lgkmcnt(7)
    v_mfma_f32_32x32x16_bf16 v[80:95], v[68:71], v[52:55], v[80:95]
    s_add_u32 s45, s55, 2
    s_and_b32 s45, s45, 7
    s_lshl_b32 s45, s45, 7
    s_add_u32 m0, s48, 59392
    s_nop 0
    buffer_load_dwordx4 v10, s[20:23], s45 offen lds
    v_mfma_f32_32x32x16_bf16 v[96:111], v[72:75], v[52:55], v[96:111]
    s_add_u32 s45, s55, 2
    s_and_b32 s45, s45, 7
    s_lshl_b32 s45, s45, 7
    s_add_u32 m0, s48, 60416
    s_nop 0
    buffer_load_dwordx4 v11, s[20:23], s45 offen lds
    v_mfma_f32_32x32x16_bf16 v[112:127], v[52:55], v[76:79], v[112:127]
    s_add_u32 s45, s55, 2
    s_and_b32 s45, s45, 7
    s_mul_i32 s45, s45, 196608
    s_add_u32 m0, s49, 57344
    s_nop 0
    buffer_load_dwordx4 v12, s[24:27], s45 offen lds
    s_add_u32 s45, s55, 2
    s_and_b32 s45, s45, 7
    s_mul_i32 s45, s45, 196608
    s_add_u32 m0, s49, 58368
    s_nop 0
    buffer_load_dwordx4 v13, s[24:27], s45 offen lds
    s_add_u32 s45, s55, 2
    s_and_b32 s45, s45, 7
    s_mul_i32 s45, s45, 196608
    s_add_u32 m0, s49, 59392
    s_nop 0
    buffer_load_dwordx4 v14, s[24:27], s45 offen lds
    s_add_u32 s45, s55, 3
    s_and_b32 s45, s45, 7
    s_lshl_b32 s45, s45, 7
    s_add_u32 m0, s48, 86016
    s_nop 0
    buffer_load_dwordx4 v8, s[20:23], s45 offen lds
    s_add_u32 s45, s55, 3
    s_and_b32 s45, s45, 7
    s_lshl_b32 s45, s45, 7
    s_add_u32 m0, s48, 87040
    s_nop 0
    buffer_load_dwordx4 v9, s[20:23], s45 offen lds
    s_add_u32 s45, s55, 3
    s_and_b32 s45, s45, 7
    s_lshl_b32 s45, s45, 7
    s_add_u32 m0, s48, 88064
    s_nop 0
    buffer_load_dwordx4 v10, s[20:23], s45 offen lds
    s_add_u32 s45, s55, 3
    s_and_b32 s45, s45, 7
    s_lshl_b32 s45, s45, 7
    s_add_u32 m0, s48, 89088
    s_nop 0
    buffer_load_dwordx4 v11, s[20:23], s45 offen lds
    s_add_u32 s45, s55, 3
    s_and_b32 s45, s45, 7
    s_mul_i32 s45, s45, 196608
    s_add_u32 m0, s49, 86016
    s_nop 0
    buffer_load_dwordx4 v12, s[24:27], s45 offen lds
    s_add_u32 s45, s55, 3
    s_and_b32 s45, s45, 7
    s_mul_i32 s45, s45, 196608
    s_add_u32 m0, s49, 87040
    s_nop 0
    buffer_load_dwordx4 v13, s[24:27], s45 offen lds
    s_add_u32 s45, s55, 3
    s_and_b32 s45, s45, 7
    s_mul_i32 s45, s45, 196608
    s_add_u32 m0, s49, 88064
    s_nop 0
    buffer_load_dwordx4 v14, s[24:27], s45 offen lds
    s_waitcnt vmcnt(14)
    s_barrier
    ds_read_b128 v[52:55], v19
    ds_read_b64_tr_b16 v[68:69], v20 offset:9216
    ds_read_b64_tr_b16 v[70:71], v20 offset:9984
    ds_read_b64_tr_b16 v[72:73], v20 offset:9280
    ds_read_b64_tr_b16 v[74:75], v20 offset:10048
    ds_read_b64_tr_b16 v[76:77], v20 offset:9344
    ds_read_b64_tr_b16 v[78:79], v20 offset:10112
    s_waitcnt lgkmcnt(7)
    v_mfma_f32_32x32x16_bf16 v[80:95], v[56:59], v[48:51], v[80:95]
    s_add_u32 s45, s55, 4
    s_and_b32 s45, s45, 7
    s_lshl_b32 s45, s45, 7
    s_add_u32 m0, s48, 114688
    s_nop 0
    buffer_load_dwordx4 v8, s[20:23], s45 offen lds
    v_mfma_f32_32x32x16_bf16 v[96:111], v[60:63], v[48:51], v[96:111]
    s_add_u32 s45, s55, 4
    s_and_b32 s45, s45, 7
    s_lshl_b32 s45, s45, 7
    s_add_u32 m0, s48, 115712
    s_nop 0
    buffer_load_dwordx4 v9, s[20:23], s45 offen lds
    v_mfma_f32_32x32x16_bf16 v[112:127], v[48:51], v[64:67], v[112:127]
    v_add_u32 v16, 28672, v16
    v_add_u32 v17, 28672, v17
    v_add_u32 v18, 28672, v18
    v_add_u32 v19, 28672, v19
    v_add_u32 v20, 28672, v20
    ds_read_b128 v[48:51], v16
    ds_read_b64_tr_b16 v[56:57], v20 offset:0
    ds_read_b64_tr_b16 v[58:59], v20 offset:768
    ds_read_b64_tr_b16 v[60:61], v20 offset:64
    ds_read_b64_tr_b16 v[62:63], v20 offset:832
    ds_read_b64_tr_b16 v[64:65], v20 offset:128
    ds_read_b64_tr_b16 v[66:67], v20 offset:896
    s_waitcnt lgkmcnt(7)
    v_mfma_f32_32x32x16_bf16 v[80:95], v[68:71], v[52:55], v[80:95]
    s_add_u32 s45, s55, 4
    s_and_b32 s45, s45, 7
    s_lshl_b32 s45, s45, 7
    s_add_u32 m0, s48, 116736
    s_nop 0
    buffer_load_dwordx4 v10, s[20:23], s45 offen lds
    v_mfma_f32_32x32x16_bf16 v[96:111], v[72:75], v[52:55], v[96:111]
    s_add_u32 s45, s55, 4
    s_and_b32 s45, s45, 7
    s_lshl_b32 s45, s45, 7
    s_add_u32 m0, s48, 117760
    s_nop 0
    buffer_load_dwordx4 v11, s[20:23], s45 offen lds
    v_mfma_f32_32x32x16_bf16 v[112:127], v[52:55], v[76:79], v[112:127]
    ds_read_b128 v[52:55], v17
    ds_read_b64_tr_b16 v[68:69], v20 offset:3072
    ds_read_b64_tr_b16 v[70:71], v20 offset:3840
    ds_read_b64_tr_b16 v[72:73], v20 offset:3136
    ds_read_b64_tr_b16 v[74:75], v20 offset:3904
    ds_read_b64_tr_b16 v[76:77], v20 offset:3200
    ds_read_b64_tr_b16 v[78:79], v20 offset:3968
    s_waitcnt lgkmcnt(7)
    v_mfma_f32_32x32x16_bf16 v[80:95], v[56:59], v[48:51], v[80:95]
    s_add_u32 s45, s55, 4
    s_and_b32 s45, s45, 7
    s_mul_i32 s45, s45, 196608
    s_add_u32 m0, s49, 114688
    s_nop 0
    buffer_load_dwordx4 v12, s[24:27], s45 offen lds
    v_mfma_f32_32x32x16_bf16 v[96:111], v[60:63], v[48:51], v[96:111]
    s_add_u32 s45, s55, 4
    s_and_b32 s45, s45, 7
    s_mul_i32 s45, s45, 196608
    s_add_u32 m0, s49, 115712
    s_nop 0
    buffer_load_dwordx4 v13, s[24:27], s45 offen lds
    v_mfma_f32_32x32x16_bf16 v[112:127], v[48:51], v[64:67], v[112:127]
    ds_read_b128 v[48:51], v18
    ds_read_b64_tr_b16 v[56:57], v20 offset:6144
    ds_read_b64_tr_b16 v[58:59], v20 offset:6912
    ds_read_b64_tr_b16 v[60:61], v20 offset:6208
    ds_read_b64_tr_b16 v[62:63], v20 offset:6976
    ds_read_b64_tr_b16 v[64:65], v20 offset:6272
    ds_read_b64_tr_b16 v[66:67], v20 offset:7040
    s_waitcnt lgkmcnt(7)
    v_mfma_f32_32x32x16_bf16 v[80:95], v[68:71], v[52:55], v[80:95]
    s_add_u32 s45, s55, 4
    s_and_b32 s45, s45, 7
    s_mul_i32 s45, s45, 196608
    s_add_u32 m0, s49, 116736
    s_nop 0
    buffer_load_dwordx4 v14, s[24:27], s45 offen lds
    v_mfma_f32_32x32x16_bf16 v[96:111], v[72:75], v[52:55], v[96:111]
    v_mfma_f32_32x32x16_bf16 v[112:127], v[52:55], v[76:79], v[112:127]
    s_waitcnt vmcnt(14)
    s_barrier
    ds_read_b128 v[52:55], v19
    ds_read_b64_tr_b16 v[68:69], v20 offset:9216
    ds_read_b64_tr_b16 v[70:71], v20 offset:9984
    ds_read_b64_tr_b16 v[72:73], v20 offset:9280
    ds_read_b64_tr_b16 v[74:75], v20 offset:10048
    ds_read_b64_tr_b16 v[76:77], v20 offset:9344
    ds_read_b64_tr_b16 v[78:79], v20 offset:10112
    s_waitcnt lgkmcnt(7)
    v_mfma_f32_32x32x16_bf16 v[80:95], v[56:59], v[48:51], v[80:95]
    s_add_u32 s45, s55, 5
    s_and_b32 s45, s45, 7
    s_lshl_b32 s45, s45, 7
    s_add_u32 m0, s48, 0
    s_nop 0
    buffer_load_dwordx4 v8, s[20:23], s45 offen lds
    v_mfma_f32_32x32x16_bf16 v[96:111], v[60:63], v[48:51], v[96:111]
    s_add_u32 s45, s55, 5
    s_and_b32 s45, s45, 7
    s_lshl_b32 s45, s45, 7
    s_add_u32 m0, s48, 1024
    s_nop 0
    buffer_load_dwordx4 v9, s[20:23], s45 offen lds
    v_mfma_f32_32x32x16_bf16 v[112:127], v[48:51], v[64:67], v[112:127]
    v_add_u32 v16, 28672, v16
    v_add_u32 v17, 28672, v17
    v_add_u32 v18, 28672, v18
    v_add_u32 v19, 28672, v19
    v_add_u32 v20, 28672, v20
    ds_read_b128 v[48:51], v16
    ds_read_b64_tr_b16 v[56:57], v20 offset:0
    ds_read_b64_tr_b16 v[58:59], v20 offset:768
    ds_read_b64_tr_b16 v[60:61], v20 offset:64
    ds_read_b64_tr_b16 v[62:63], v20 offset:832
    ds_read_b64_tr_b16 v[64:65], v20 offset:128
    ds_read_b64_tr_b16 v[66:67], v20 offset:896
    s_waitcnt lgkmcnt(7)
    v_mfma_f32_32x32x16_bf16 v[80:95], v[68:71], v[52:55], v[80:95]
    s_add_u32 s45, s55, 5
    s_and_b32 s45, s45, 7
    s_lshl_b32 s45, s45, 7
    s_add_u32 m0, s48, 2048
    s_nop 0
    buffer_load_dwordx4 v10, s[20:23], s45 offen lds
    v_mfma_f32_32x32x16_bf16 v[96:111], v[72:75], v[52:55], v[96:111]
    s_add_u32 s45, s55, 5
    s_and_b32 s45, s45, 7
    s_lshl_b32 s45, s45, 7
    s_add_u32 m0, s48, 3072
    s_nop 0
    buffer_load_dwordx4 v11, s[20:23], s45 offen lds
    v_mfma_f32_32x32x16_bf16 v[112:127], v[52:55], v[76:79], v[112:127]
    ds_read_b128 v[52:55], v17
    ds_read_b64_tr_b16 v[68:69], v20 offset:3072
    ds_read_b64_tr_b16 v[70:71], v20 offset:3840
    ds_read_b64_tr_b16 v[72:73], v20 offset:3136
    ds_read_b64_tr_b16 v[74:75], v20 offset:3904
    ds_read_b64_tr_b16 v[76:77], v20 offset:3200
    ds_read_b64_tr_b16 v[78:79], v20 offset:3968
    s_waitcnt lgkmcnt(7)
    v_mfma_f32_32x32x16_bf16 v[80:95], v[56:59], v[48:51], v[80:95]
    s_add_u32 s45, s55, 5
    s_and_b32 s45, s45, 7
    s_mul_i32 s45, s45, 196608
    s_add_u32 m0, s49, 0
    s_nop 0
    buffer_load_dwordx4 v12, s[24:27], s45 offen lds
    v_mfma_f32_32x32x16_bf16 v[96:111], v[60:63], v[48:51], v[96:111]
    s_add_u32 s45, s55, 5
    s_and_b32 s45, s45, 7
    s_mul_i32 s45, s45, 196608
    s_add_u32 m0, s49, 1024
    s_nop 0
    buffer_load_dwordx4 v13, s[24:27], s45 offen lds
    v_mfma_f32_32x32x16_bf16 v[112:127], v[48:51], v[64:67], v[112:127]
    ds_read_b128 v[48:51], v18
    ds_read_b64_tr_b16 v[56:57], v20 offset:6144
    ds_read_b64_tr_b16 v[58:59], v20 offset:6912
    ds_read_b64_tr_b16 v[60:61], v20 offset:6208
    ds_read_b64_tr_b16 v[62:63], v20 offset:6976
    ds_read_b64_tr_b16 v[64:65], v20 offset:6272
    ds_read_b64_tr_b16 v[66:67], v20 offset:7040
    s_waitcnt lgkmcnt(7)
    v_mfma_f32_32x32x16_bf16 v[80:95], v[68:71], v[52:55], v[80:95]
    s_add_u32 s45, s55, 5
    s_and_b32 s45, s45, 7
    s_mul_i32 s45, s45, 196608
    s_add_u32 m0, s49, 2048
    s_nop 0
    buffer_load_dwordx4 v14, s[24:27], s45 offen lds
    v_mfma_f32_32x32x16_bf16 v[96:111], v[72:75], v[52:55], v[96:111]
    v_mfma_f32_32x32x16_bf16 v[112:127], v[52:55], v[76:79], v[112:127]
    s_waitcnt vmcnt(14)
    s_barrier
    ds_read_b128 v[52:55], v19
    ds_read_b64_tr_b16 v[68:69], v20 offset:9216
    ds_read_b64_tr_b16 v[70:71], v20 offset:9984
    ds_read_b64_tr_b16 v[72:73], v20 offset:9280
    ds_read_b64_tr_b16 v[74:75], v20 offset:10048
    ds_read_b64_tr_b16 v[76:77], v20 offset:9344
    ds_read_b64_tr_b16 v[78:79], v20 offset:10112
    s_waitcnt lgkmcnt(7)
    v_mfma_f32_32x32x16_bf16 v[80:95], v[56:59], v[48:51], v[80:95]
    s_add_u32 s45, s55, 6
    s_and_b32 s45, s45, 7
    s_lshl_b32 s45, s45, 7
    s_add_u32 m0, s48, 28672
    s_nop 0
    buffer_load_dwordx4 v8, s[20:23], s45 offen lds
    v_mfma_f32_32x32x16_bf16 v[96:111], v[60:63], v[48:51], v[96:111]
    s_add_u32 s45, s55, 6
    s_and_b32 s45, s45, 7
    s_lshl_b32 s45, s45, 7
    s_add_u32 m0, s48, 29696
    s_nop 0
    buffer_load_dwordx4 v9, s[20:23], s45 offen lds
    v_mfma_f32_32x32x16_bf16 v[112:127], v[48:51], v[64:67], v[112:127]
    v_add_u32 v16, 28672, v16
    v_add_u32 v17, 28672, v17
    v_add_u32 v18, 28672, v18
    v_add_u32 v19, 28672, v19
    v_add_u32 v20, 28672, v20
    ds_read_b128 v[48:51], v16
    ds_read_b64_tr_b16 v[56:57], v20 offset:0
    ds_read_b64_tr_b16 v[58:59], v20 offset:768
    ds_read_b64_tr_b16 v[60:61], v20 offset:64
    ds_read_b64_tr_b16 v[62:63], v20 offset:832
    ds_read_b64_tr_b16 v[64:65], v20 offset:128
    ds_read_b64_tr_b16 v[66:67], v20 offset:896
    s_waitcnt lgkmcnt(7)
    v_mfma_f32_32x32x16_bf16 v[80:95], v[68:71], v[52:55], v[80:95]
    s_add_u32 s45, s55, 6
    s_and_b32 s45, s45, 7
    s_lshl_b32 s45, s45, 7
    s_add_u32 m0, s48, 30720
    s_nop 0
    buffer_load_dwordx4 v10, s[20:23], s45 offen lds
    v_mfma_f32_32x32x16_bf16 v[96:111], v[72:75], v[52:55], v[96:111]
    s_add_u32 s45, s55, 6
    s_and_b32 s45, s45, 7
    s_lshl_b32 s45, s45, 7
    s_add_u32 m0, s48, 31744
    s_nop 0
    buffer_load_dwordx4 v11, s[20:23], s45 offen lds
    v_mfma_f32_32x32x16_bf16 v[112:127], v[52:55], v[76:79], v[112:127]
    ds_read_b128 v[52:55], v17
    ds_read_b64_tr_b16 v[68:69], v20 offset:3072
    ds_read_b64_tr_b16 v[70:71], v20 offset:3840
    ds_read_b64_tr_b16 v[72:73], v20 offset:3136
    ds_read_b64_tr_b16 v[74:75], v20 offset:3904
    ds_read_b64_tr_b16 v[76:77], v20 offset:3200
    ds_read_b64_tr_b16 v[78:79], v20 offset:3968
    s_waitcnt lgkmcnt(7)
    v_mfma_f32_32x32x16_bf16 v[80:95], v[56:59], v[48:51], v[80:95]
    s_add_u32 s45, s55, 6
    s_and_b32 s45, s45, 7
    s_mul_i32 s45, s45, 196608
    s_add_u32 m0, s49, 28672
    s_nop 0
    buffer_load_dwordx4 v12, s[24:27], s45 offen lds
    v_mfma_f32_32x32x16_bf16 v[96:111], v[60:63], v[48:51], v[96:111]
    s_add_u32 s45, s55, 6
    s_and_b32 s45, s45, 7
    s_mul_i32 s45, s45, 196608
    s_add_u32 m0, s49, 29696
    s_nop 0
    buffer_load_dwordx4 v13, s[24:27], s45 offen lds
    v_mfma_f32_32x32x16_bf16 v[112:127], v[48:51], v[64:67], v[112:127]
    ds_read_b128 v[48:51], v18
    ds_read_b64_tr_b16 v[56:57], v20 offset:6144
    ds_read_b64_tr_b16 v[58:59], v20 offset:6912
    ds_read_b64_tr_b16 v[60:61], v20 offset:6208
    ds_read_b64_tr_b16 v[62:63], v20 offset:6976
    ds_read_b64_tr_b16 v[64:65], v20 offset:6272
    ds_read_b64_tr_b16 v[66:67], v20 offset:7040
    s_waitcnt lgkmcnt(7)
    v_mfma_f32_32x32x16_bf16 v[80:95], v[68:71], v[52:55], v[80:95]
    s_add_u32 s45, s55, 6
    s_and_b32 s45, s45, 7
    s_mul_i32 s45, s45, 196608
    s_add_u32 m0, s49, 30720
    s_nop 0
    buffer_load_dwordx4 v14, s[24:27], s45 offen lds
    v_mfma_f32_32x32x16_bf16 v[96:111], v[72:75], v[52:55], v[96:111]
    v_mfma_f32_32x32x16_bf16 v[112:127], v[52:55], v[76:79], v[112:127]
    s_waitcnt vmcnt(14)
    s_barrier
    ds_read_b128 v[52:55], v19
    ds_read_b64_tr_b16 v[68:69], v20 offset:9216
    ds_read_b64_tr_b16 v[70:71], v20 offset:9984
    ds_read_b64_tr_b16 v[72:73], v20 offset:9280
    ds_read_b64_tr_b16 v[74:75], v20 offset:10048
    ds_read_b64_tr_b16 v[76:77], v20 offset:9344
    ds_read_b64_tr_b16 v[78:79], v20 offset:10112
    s_waitcnt lgkmcnt(7)
    v_mfma_f32_32x32x16_bf16 v[80:95], v[56:59], v[48:51], v[80:95]
    s_add_u32 s45, s55, 7
    s_and_b32 s45, s45, 7
    s_lshl_b32 s45, s45, 7
    s_add_u32 m0, s48, 57344
    s_nop 0
    buffer_load_dwordx4 v8, s[20:23], s45 offen lds
    v_mfma_f32_32x32x16_bf16 v[96:111], v[60:63], v[48:51], v[96:111]
    s_add_u32 s45, s55, 7
    s_and_b32 s45, s45, 7
    s_lshl_b32 s45, s45, 7
    s_add_u32 m0, s48, 58368
    s_nop 0
    buffer_load_dwordx4 v9, s[20:23], s45 offen lds
    v_mfma_f32_32x32x16_bf16 v[112:127], v[48:51], v[64:67], v[112:127]
    v_add_u32 v16, 28672, v16
    v_add_u32 v17, 28672, v17
    v_add_u32 v18, 28672, v18
    v_add_u32 v19, 28672, v19
    v_add_u32 v20, 28672, v20
    ds_read_b128 v[48:51], v16
    ds_read_b64_tr_b16 v[56:57], v20 offset:0
    ds_read_b64_tr_b16 v[58:59], v20 offset:768
    ds_read_b64_tr_b16 v[60:61], v20 offset:64
    ds_read_b64_tr_b16 v[62:63], v20 offset:832
    ds_read_b64_tr_b16 v[64:65], v20 offset:128
    ds_read_b64_tr_b16 v[66:67], v20 offset:896
    s_waitcnt lgkmcnt(7)
    v_mfma_f32_32x32x16_bf16 v[80:95], v[68:71], v[52:55], v[80:95]
    s_add_u32 s45, s55, 7
    s_and_b32 s45, s45, 7
    s_lshl_b32 s45, s45, 7
    s_add_u32 m0, s48, 59392
    s_nop 0
    buffer_load_dwordx4 v10, s[20:23], s45 offen lds
    v_mfma_f32_32x32x16_bf16 v[96:111], v[72:75], v[52:55], v[96:111]
    s_add_u32 s45, s55, 7
    s_and_b32 s45, s45, 7
    s_lshl_b32 s45, s45, 7
    s_add_u32 m0, s48, 60416
    s_nop 0
    buffer_load_dwordx4 v11, s[20:23], s45 offen lds
    v_mfma_f32_32x32x16_bf16 v[112:127], v[52:55], v[76:79], v[112:127]
    ds_read_b128 v[52:55], v17
    ds_read_b64_tr_b16 v[68:69], v20 offset:3072
    ds_read_b64_tr_b16 v[70:71], v20 offset:3840
    ds_read_b64_tr_b16 v[72:73], v20 offset:3136
    ds_read_b64_tr_b16 v[74:75], v20 offset:3904
    ds_read_b64_tr_b16 v[76:77], v20 offset:3200
    ds_read_b64_tr_b16 v[78:79], v20 offset:3968
    s_waitcnt lgkmcnt(7)
    v_mfma_f32_32x32x16_bf16 v[80:95], v[56:59], v[48:51], v[80:95]
    s_add_u32 s45, s55, 7
    s_and_b32 s45, s45, 7
    s_mul_i32 s45, s45, 196608
    s_add_u32 m0, s49, 57344
    s_nop 0
    buffer_load_dwordx4 v12, s[24:27], s45 offen lds
    v_mfma_f32_32x32x16_bf16 v[96:111], v[60:63], v[48:51], v[96:111]
    s_add_u32 s45, s55, 7
    s_and_b32 s45, s45, 7
    s_mul_i32 s45, s45, 196608
    s_add_u32 m0, s49, 58368
    s_nop 0
    buffer_load_dwordx4 v13, s[24:27], s45 offen lds
    v_mfma_f32_32x32x16_bf16 v[112:127], v[48:51], v[64:67], v[112:127]
    ds_read_b128 v[48:51], v18
    ds_read_b64_tr_b16 v[56:57], v20 offset:6144
    ds_read_b64_tr_b16 v[58:59], v20 offset:6912
    ds_read_b64_tr_b16 v[60:61], v20 offset:6208
    ds_read_b64_tr_b16 v[62:63], v20 offset:6976
    ds_read_b64_tr_b16 v[64:65], v20 offset:6272
    ds_read_b64_tr_b16 v[66:67], v20 offset:7040
    s_waitcnt lgkmcnt(7)
    v_mfma_f32_32x32x16_bf16 v[80:95], v[68:71], v[52:55], v[80:95]
    s_add_u32 s45, s55, 7
    s_and_b32 s45, s45, 7
    s_mul_i32 s45, s45, 196608
    s_add_u32 m0, s49, 59392
    s_nop 0
    buffer_load_dwordx4 v14, s[24:27], s45 offen lds
    v_mfma_f32_32x32x16_bf16 v[96:111], v[72:75], v[52:55], v[96:111]
    v_mfma_f32_32x32x16_bf16 v[112:127], v[52:55], v[76:79], v[112:127]
    s_waitcnt vmcnt(14)
    s_barrier
    ds_read_b128 v[52:55], v19
    ds_read_b64_tr_b16 v[68:69], v20 offset:9216
    ds_read_b64_tr_b16 v[70:71], v20 offset:9984
    ds_read_b64_tr_b16 v[72:73], v20 offset:9280
    ds_read_b64_tr_b16 v[74:75], v20 offset:10048
    ds_read_b64_tr_b16 v[76:77], v20 offset:9344
    ds_read_b64_tr_b16 v[78:79], v20 offset:10112
    s_waitcnt lgkmcnt(7)
    v_mfma_f32_32x32x16_bf16 v[80:95], v[56:59], v[48:51], v[80:95]
    v_mfma_f32_32x32x16_bf16 v[96:111], v[60:63], v[48:51], v[96:111]
    v_mfma_f32_32x32x16_bf16 v[112:127], v[48:51], v[64:67], v[112:127]
    v_subrev_u32 v16, 114688, v16
    v_subrev_u32 v17, 114688, v17
    v_subrev_u32 v18, 114688, v18
    v_subrev_u32 v19, 114688, v19
    v_subrev_u32 v20, 114688, v20
    ds_read_b128 v[48:51], v16
    ds_read_b64_tr_b16 v[56:57], v20 offset:0
    ds_read_b64_tr_b16 v[58:59], v20 offset:768
    ds_read_b64_tr_b16 v[60:61], v20 offset:64
    ds_read_b64_tr_b16 v[62:63], v20 offset:832
    ds_read_b64_tr_b16 v[64:65], v20 offset:128
    ds_read_b64_tr_b16 v[66:67], v20 offset:896
    s_waitcnt lgkmcnt(7)
    v_mfma_f32_32x32x16_bf16 v[80:95], v[68:71], v[52:55], v[80:95]
    v_mfma_f32_32x32x16_bf16 v[96:111], v[72:75], v[52:55], v[96:111]
    v_mfma_f32_32x32x16_bf16 v[112:127], v[52:55], v[76:79], v[112:127]
    ds_read_b128 v[52:55], v17
    ds_read_b64_tr_b16 v[68:69], v20 offset:3072
    ds_read_b64_tr_b16 v[70:71], v20 offset:3840
    ds_read_b64_tr_b16 v[72:73], v20 offset:3136
    ds_read_b64_tr_b16 v[74:75], v20 offset:3904
    ds_read_b64_tr_b16 v[76:77], v20 offset:3200
    ds_read_b64_tr_b16 v[78:79], v20 offset:3968
    s_waitcnt lgkmcnt(7)
    v_mfma_f32_32x32x16_bf16 v[80:95], v[56:59], v[48:51], v[80:95]
    v_mfma_f32_32x32x16_bf16 v[96:111], v[60:63], v[48:51], v[96:111]
    v_mfma_f32_32x32x16_bf16 v[112:127], v[48:51], v[64:67], v[112:127]
    ds_read_b128 v[48:51], v18
    ds_read_b64_tr_b16 v[56:57], v20 offset:6144
    ds_read_b64_tr_b16 v[58:59], v20 offset:6912
    ds_read_b64_tr_b16 v[60:61], v20 offset:6208
    ds_read_b64_tr_b16 v[62:63], v20 offset:6976
    ds_read_b64_tr_b16 v[64:65], v20 offset:6272
    ds_read_b64_tr_b16 v[66:67], v20 offset:7040
    s_waitcnt lgkmcnt(7)
    v_mfma_f32_32x32x16_bf16 v[80:95], v[68:71], v[52:55], v[80:95]
    v_mfma_f32_32x32x16_bf16 v[96:111], v[72:75], v[52:55], v[96:111]
    v_mfma_f32_32x32x16_bf16 v[112:127], v[52:55], v[76:79], v[112:127]
    s_waitcnt vmcnt(7)
    s_barrier
    ds_read_b128 v[52:55], v19
    ds_read_b64_tr_b16 v[68:69], v20 offset:9216
    ds_read_b64_tr_b16 v[70:71], v20 offset:9984
    ds_read_b64_tr_b16 v[72:73], v20 offset:9280
    ds_read_b64_tr_b16 v[74:75], v20 offset:10048
    ds_read_b64_tr_b16 v[76:77], v20 offset:9344
    ds_read_b64_tr_b16 v[78:79], v20 offset:10112
    s_waitcnt lgkmcnt(7)
    v_mfma_f32_32x32x16_bf16 v[80:95], v[56:59], v[48:51], v[80:95]
    v_mfma_f32_32x32x16_bf16 v[96:111], v[60:63], v[48:51], v[96:111]
    v_mfma_f32_32x32x16_bf16 v[112:127], v[48:51], v[64:67], v[112:127]
    v_add_u32 v16, 28672, v16
    v_add_u32 v17, 28672, v17
    v_add_u32 v18, 28672, v18
    v_add_u32 v19, 28672, v19
    v_add_u32 v20, 28672, v20
    ds_read_b128 v[48:51], v16
    ds_read_b64_tr_b16 v[56:57], v20 offset:0
    ds_read_b64_tr_b16 v[58:59], v20 offset:768
    ds_read_b64_tr_b16 v[60:61], v20 offset:64
    ds_read_b64_tr_b16 v[62:63], v20 offset:832
    ds_read_b64_tr_b16 v[64:65], v20 offset:128
    ds_read_b64_tr_b16 v[66:67], v20 offset:896
    s_waitcnt lgkmcnt(7)
    v_mfma_f32_32x32x16_bf16 v[80:95], v[68:71], v[52:55], v[80:95]
    v_mfma_f32_32x32x16_bf16 v[96:111], v[72:75], v[52:55], v[96:111]
    v_mfma_f32_32x32x16_bf16 v[112:127], v[52:55], v[76:79], v[112:127]
    ds_read_b128 v[52:55], v17
    ds_read_b64_tr_b16 v[68:69], v20 offset:3072
    ds_read_b64_tr_b16 v[70:71], v20 offset:3840
    ds_read_b64_tr_b16 v[72:73], v20 offset:3136
    ds_read_b64_tr_b16 v[74:75], v20 offset:3904
    ds_read_b64_tr_b16 v[76:77], v20 offset:3200
    ds_read_b64_tr_b16 v[78:79], v20 offset:3968
    s_waitcnt lgkmcnt(7)
    v_mfma_f32_32x32x16_bf16 v[80:95], v[56:59], v[48:51], v[80:95]
    v_mfma_f32_32x32x16_bf16 v[96:111], v[60:63], v[48:51], v[96:111]
    v_mfma_f32_32x32x16_bf16 v[112:127], v[48:51], v[64:67], v[112:127]
    ds_read_b128 v[48:51], v18
    ds_read_b64_tr_b16 v[56:57], v20 offset:6144
    ds_read_b64_tr_b16 v[58:59], v20 offset:6912
    ds_read_b64_tr_b16 v[60:61], v20 offset:6208
    ds_read_b64_tr_b16 v[62:63], v20 offset:6976
    ds_read_b64_tr_b16 v[64:65], v20 offset:6272
    ds_read_b64_tr_b16 v[66:67], v20 offset:7040
    s_waitcnt lgkmcnt(7)
    v_mfma_f32_32x32x16_bf16 v[80:95], v[68:71], v[52:55], v[80:95]
    v_mfma_f32_32x32x16_bf16 v[96:111], v[72:75], v[52:55], v[96:111]
    v_mfma_f32_32x32x16_bf16 v[112:127], v[52:55], v[76:79], v[112:127]
    s_waitcnt vmcnt(0)
    s_barrier
    ds_read_b128 v[52:55], v19
    ds_read_b64_tr_b16 v[68:69], v20 offset:9216
    ds_read_b64_tr_b16 v[70:71], v20 offset:9984
    ds_read_b64_tr_b16 v[72:73], v20 offset:9280
    ds_read_b64_tr_b16 v[74:75], v20 offset:10048
    ds_read_b64_tr_b16 v[76:77], v20 offset:9344
    ds_read_b64_tr_b16 v[78:79], v20 offset:10112
    s_waitcnt lgkmcnt(7)
    v_mfma_f32_32x32x16_bf16 v[80:95], v[56:59], v[48:51], v[80:95]
    v_mfma_f32_32x32x16_bf16 v[96:111], v[60:63], v[48:51], v[96:111]
    v_mfma_f32_32x32x16_bf16 v[112:127], v[48:51], v[64:67], v[112:127]
    v_add_u32 v16, 28672, v16
    v_add_u32 v17, 28672, v17
    v_add_u32 v18, 28672, v18
    v_add_u32 v19, 28672, v19
    v_add_u32 v20, 28672, v20
    ds_read_b128 v[48:51], v16
    ds_read_b64_tr_b16 v[56:57], v20 offset:0
    ds_read_b64_tr_b16 v[58:59], v20 offset:768
    ds_read_b64_tr_b16 v[60:61], v20 offset:64
    ds_read_b64_tr_b16 v[62:63], v20 offset:832
    ds_read_b64_tr_b16 v[64:65], v20 offset:128
    ds_read_b64_tr_b16 v[66:67], v20 offset:896
    s_waitcnt lgkmcnt(7)
    v_mfma_f32_32x32x16_bf16 v[80:95], v[68:71], v[52:55], v[80:95]
    v_mfma_f32_32x32x16_bf16 v[96:111], v[72:75], v[52:55], v[96:111]
    v_mfma_f32_32x32x16_bf16 v[112:127], v[52:55], v[76:79], v[112:127]
    ds_read_b128 v[52:55], v17
    ds_read_b64_tr_b16 v[68:69], v20 offset:3072
    ds_read_b64_tr_b16 v[70:71], v20 offset:3840
    ds_read_b64_tr_b16 v[72:73], v20 offset:3136
    ds_read_b64_tr_b16 v[74:75], v20 offset:3904
    ds_read_b64_tr_b16 v[76:77], v20 offset:3200
    ds_read_b64_tr_b16 v[78:79], v20 offset:3968
    s_waitcnt lgkmcnt(7)
    v_mfma_f32_32x32x16_bf16 v[80:95], v[56:59], v[48:51], v[80:95]
    v_mfma_f32_32x32x16_bf16 v[96:111], v[60:63], v[48:51], v[96:111]
    v_mfma_f32_32x32x16_bf16 v[112:127], v[48:51], v[64:67], v[112:127]
    ds_read_b128 v[48:51], v18
    ds_read_b64_tr_b16 v[56:57], v20 offset:6144
    ds_read_b64_tr_b16 v[58:59], v20 offset:6912
    ds_read_b64_tr_b16 v[60:61], v20 offset:6208
    ds_read_b64_tr_b16 v[62:63], v20 offset:6976
    ds_read_b64_tr_b16 v[64:65], v20 offset:6272
    ds_read_b64_tr_b16 v[66:67], v20 offset:7040
    s_waitcnt lgkmcnt(7)
    v_mfma_f32_32x32x16_bf16 v[80:95], v[68:71], v[52:55], v[80:95]
    v_mfma_f32_32x32x16_bf16 v[96:111], v[72:75], v[52:55], v[96:111]
    v_mfma_f32_32x32x16_bf16 v[112:127], v[52:55], v[76:79], v[112:127]
    ds_read_b128 v[52:55], v19
    ds_read_b64_tr_b16 v[68:69], v20 offset:9216
    ds_read_b64_tr_b16 v[70:71], v20 offset:9984
    ds_read_b64_tr_b16 v[72:73], v20 offset:9280
    ds_read_b64_tr_b16 v[74:75], v20 offset:10048
    ds_read_b64_tr_b16 v[76:77], v20 offset:9344
    ds_read_b64_tr_b16 v[78:79], v20 offset:10112
    s_waitcnt lgkmcnt(7)
    v_mfma_f32_32x32x16_bf16 v[80:95], v[56:59], v[48:51], v[80:95]
    v_mfma_f32_32x32x16_bf16 v[96:111], v[60:63], v[48:51], v[96:111]
    v_mfma_f32_32x32x16_bf16 v[112:127], v[48:51], v[64:67], v[112:127]
    s_waitcnt lgkmcnt(0)
    v_mfma_f32_32x32x16_bf16 v[80:95], v[68:71], v[52:55], v[80:95]
    v_mfma_f32_32x32x16_bf16 v[96:111], v[72:75], v[52:55], v[96:111]
    v_mfma_f32_32x32x16_bf16 v[112:127], v[52:55], v[76:79], v[112:127]
    s_branch K1_EPI
K1_NNN:
    s_waitcnt vmcnt(7)
    s_barrier
    ds_read_b128 v[48:51], v16
    ds_read_b64_tr_b16 v[56:57], v20 offset:0
    ds_read_b64_tr_b16 v[58:59], v20 offset:768
    ds_read_b64_tr_b16 v[60:61], v20 offset:64
    ds_read_b64_tr_b16 v[62:63], v20 offset:832
    ds_read_b64_tr_b16 v[64:65], v20 offset:128
    ds_read_b64_tr_b16 v[66:67], v20 offset:896
    ds_read_b128 v[52:55], v17
    ds_read_b64_tr_b16 v[68:69], v20 offset:3072
    ds_read_b64_tr_b16 v[70:71], v20 offset:3840
    ds_read_b64_tr_b16 v[72:73], v20 offset:3136
    ds_read_b64_tr_b16 v[74:75], v20 offset:3904
    ds_read_b64_tr_b16 v[76:77], v20 offset:3200
    ds_read_b64_tr_b16 v[78:79], v20 offset:3968
    s_waitcnt lgkmcnt(7)
    v_mfma_f32_32x32x16_bf16 v[80:95], v[48:51], v[56:59], v[80:95]
    s_add_u32 s45, s55, 2
    s_and_b32 s45, s45, 7
    s_lshl_b32 s45, s45, 7
    s_add_u32 m0, s48, 57344
    s_nop 0
    buffer_load_dwordx4 v8, s[20:23], s45 offen lds
    v_mfma_f32_32x32x16_bf16 v[96:111], v[48:51], v[60:63], v[96:111]
    s_add_u32 s45, s55, 2
    s_and_b32 s45, s45, 7
    s_lshl_b32 s45, s45, 7
    s_add_u32 m0, s48, 58368
    s_nop 0
    buffer_load_dwordx4 v9, s[20:23], s45 offen lds
    v_mfma_f32_32x32x16_bf16 v[112:127], v[48:51], v[64:67], v[112:127]
    ds_read_b128 v[48:51], v18
    ds_read_b64_tr_b16 v[56:57], v20 offset:6144
    ds_read_b64_tr_b16 v[58:59], v20 offset:6912
    ds_read_b64_tr_b16 v[60:61], v20 offset:6208
    ds_read_b64_tr_b16 v[62:63], v20 offset:6976
    ds_read_b64_tr_b16 v[64:65], v20 offset:6272
    ds_read_b64_tr_b16 v[66:67], v20 offset:7040
    s_waitcnt lgkmcnt(7)
    v_mfma_f32_32x32x16_bf16 v[80:95], v[52:55], v[68:71], v[80:95]
    s_add_u32 s45, s55, 2
    s_and_b32 s45, s45, 7
    s_lshl_b32 s45, s45, 7
    s_add_u32 m0, s48, 59392
    s_nop 0
    buffer_load_dwordx4 v10, s[20:23], s45 offen lds
    v_mfma_f32_32x32x16_bf16 v[96:111], v[52:55], v[72:75], v[96:111]
    s_add_u32 s45, s55, 2
    s_and_b32 s45, s45, 7
    s_lshl_b32 s45, s45, 7
    s_add_u32 m0, s48, 60416
    s_nop 0
    buffer_load_dwordx4 v11, s[20:23], s45 offen lds
    v_mfma_f32_32x32x16_bf16 v[112:127], v[52:55], v[76:79], v[112:127]
    s_add_u32 s45, s55, 2
    s_and_b32 s45, s45, 7
    s_mul_i32 s45, s45, 196608
    s_add_u32 m0, s49, 57344
    s_nop 0
    buffer_load_dwordx4 v12, s[24:27], s45 offen lds
    s_add_u32 s45, s55, 2
    s_and_b32 s45, s45, 7
    s_mul_i32 s45, s45, 196608
    s_add_u32 m0, s49, 58368
    s_nop 0
    buffer_load_dwordx4 v13, s[24:27], s45 offen lds
    s_add_u32 s45, s55, 2
    s_and_b32 s45, s45, 7
    s_mul_i32 s45, s45, 196608
    s_add_u32 m0, s49, 59392
    s_nop 0
    buffer_load_dwordx4 v14, s[24:27], s45 offen lds
    s_add_u32 s45, s55, 3
    s_and_b32 s45, s45, 7
    s_lshl_b32 s45, s45, 7
    s_add_u32 m0, s48, 86016
    s_nop 0
    buffer_load_dwordx4 v8, s[20:23], s45 offen lds
    s_add_u32 s45, s55, 3
    s_and_b32 s45, s45, 7
    s_lshl_b32 s45, s45, 7
    s_add_u32 m0, s48, 87040
    s_nop 0
    buffer_load_dwordx4 v9, s[20:23], s45 offen lds
    s_add_u32 s45, s55, 3
    s_and_b32 s45, s45, 7
    s_lshl_b32 s45, s45, 7
    s_add_u32 m0, s48, 88064
    s_nop 0
    buffer_load_dwordx4 v10, s[20:23], s45 offen lds
    s_add_u32 s45, s55, 3
    s_and_b32 s45, s45, 7
    s_lshl_b32 s45, s45, 7
    s_add_u32 m0, s48, 89088
    s_nop 0
    buffer_load_dwordx4 v11, s[20:23], s45 offen lds
    s_add_u32 s45, s55, 3
    s_and_b32 s45, s45, 7
    s_mul_i32 s45, s45, 196608
    s_add_u32 m0, s49, 86016
    s_nop 0
    buffer_load_dwordx4 v12, s[24:27], s45 offen lds
    s_add_u32 s45, s55, 3
    s_and_b32 s45, s45, 7
    s_mul_i32 s45, s45, 196608
    s_add_u32 m0, s49, 87040
    s_nop 0
    buffer_load_dwordx4 v13, s[24:27], s45 offen lds
    s_add_u32 s45, s55, 3
    s_and_b32 s45, s45, 7
    s_mul_i32 s45, s45, 196608
    s_add_u32 m0, s49, 88064
    s_nop 0
    buffer_load_dwordx4 v14, s[24:27], s45 offen lds
    s_waitcnt vmcnt(14)
    s_barrier
    ds_read_b128 v[52:55], v19
    ds_read_b64_tr_b16 v[68:69], v20 offset:9216
    ds_read_b64_tr_b16 v[70:71], v20 offset:9984
    ds_read_b64_tr_b16 v[72:73], v20 offset:9280
    ds_read_b64_tr_b16 v[74:75], v20 offset:10048
    ds_read_b64_tr_b16 v[76:77], v20 offset:9344
    ds_read_b64_tr_b16 v[78:79], v20 offset:10112
    s_waitcnt lgkmcnt(7)
    v_mfma_f32_32x32x16_bf16 v[80:95], v[48:51], v[56:59], v[80:95]
    s_add_u32 s45, s55, 4
    s_and_b32 s45, s45, 7
    s_lshl_b32 s45, s45, 7
    s_add_u32 m0, s48, 114688
    s_nop 0
    buffer_load_dwordx4 v8, s[20:23], s45 offen lds
    v_mfma_f32_32x32x16_bf16 v[96:111], v[48:51], v[60:63], v[96:111]
    s_add_u32 s45, s55, 4
    s_and_b32 s45, s45, 7
    s_lshl_b32 s45, s45, 7
    s_add_u32 m0, s48, 115712
    s_nop 0
    buffer_load_dwordx4 v9, s[20:23], s45 offen lds
    v_mfma_f32_32x32x16_bf16 v[112:127], v[48:51], v[64:67], v[112:127]
    v_add_u32 v16, 28672, v16
    v_add_u32 v17, 28672, v17
    v_add_u32 v18, 28672, v18
    v_add_u32 v19, 28672, v19
    v_add_u32 v20, 28672, v20
    ds_read_b128 v[48:51], v16
    ds_read_b64_tr_b16 v[56:57], v20 offset:0
    ds_read_b64_tr_b16 v[58:59], v20 offset:768
    ds_read_b64_tr_b16 v[60:61], v20 offset:64
    ds_read_b64_tr_b16 v[62:63], v20 offset:832
    ds_read_b64_tr_b16 v[64:65], v20 offset:128
    ds_read_b64_tr_b16 v[66:67], v20 offset:896
    s_waitcnt lgkmcnt(7)
    v_mfma_f32_32x32x16_bf16 v[80:95], v[52:55], v[68:71], v[80:95]
    s_add_u32 s45, s55, 4
    s_and_b32 s45, s45, 7
    s_lshl_b32 s45, s45, 7
    s_add_u32 m0, s48, 116736
    s_nop 0
    buffer_load_dwordx4 v10, s[20:23], s45 offen lds
    v_mfma_f32_32x32x16_bf16 v[96:111], v[52:55], v[72:75], v[96:111]
    s_add_u32 s45, s55, 4
    s_and_b32 s45, s45, 7
    s_lshl_b32 s45, s45, 7
    s_add_u32 m0, s48, 117760
    s_nop 0
    buffer_load_dwordx4 v11, s[20:23], s45 offen lds
    v_mfma_f32_32x32x16_bf16 v[112:127], v[52:55], v[76:79], v[112:127]
    ds_read_b128 v[52:55], v17
    ds_read_b64_tr_b16 v[68:69], v20 offset:3072
    ds_read_b64_tr_b16 v[70:71], v20 offset:3840
    ds_read_b64_tr_b16 v[72:73], v20 offset:3136
    ds_read_b64_tr_b16 v[74:75], v20 offset:3904
    ds_read_b64_tr_b16 v[76:77], v20 offset:3200
    ds_read_b64_tr_b16 v[78:79], v20 offset:3968
    s_waitcnt lgkmcnt(7)
    v_mfma_f32_32x32x16_bf16 v[80:95], v[48:51], v[56:59], v[80:95]
    s_add_u32 s45, s55, 4
    s_and_b32 s45, s45, 7
    s_mul_i32 s45, s45, 196608
    s_add_u32 m0, s49, 114688
    s_nop 0
    buffer_load_dwordx4 v12, s[24:27], s45 offen lds
    v_mfma_f32_32x32x16_bf16 v[96:111], v[48:51], v[60:63], v[96:111]
    s_add_u32 s45, s55, 4
    s_and_b32 s45, s45, 7
    s_mul_i32 s45, s45, 196608
    s_add_u32 m0, s49, 115712
    s_nop 0
    buffer_load_dwordx4 v13, s[24:27], s45 offen lds
    v_mfma_f32_32x32x16_bf16 v[112:127], v[48:51], v[64:67], v[112:127]
    ds_read_b128 v[48:51], v18
    ds_read_b64_tr_b16 v[56:57], v20 offset:6144
    ds_read_b64_tr_b16 v[58:59], v20 offset:6912
    ds_read_b64_tr_b16 v[60:61], v20 offset:6208
    ds_read_b64_tr_b16 v[62:63], v20 offset:6976
    ds_read_b64_tr_b16 v[64:65], v20 offset:6272
    ds_read_b64_tr_b16 v[66:67], v20 offset:7040
    s_waitcnt lgkmcnt(7)
    v_mfma_f32_32x32x16_bf16 v[80:95], v[52:55], v[68:71], v[80:95]
    s_add_u32 s45, s55, 4
    s_and_b32 s45, s45, 7
    s_mul_i32 s45, s45, 196608
    s_add_u32 m0, s49, 116736
    s_nop 0
    buffer_load_dwordx4 v14, s[24:27], s45 offen lds
    v_mfma_f32_32x32x16_bf16 v[96:111], v[52:55], v[72:75], v[96:111]
    v_mfma_f32_32x32x16_bf16 v[112:127], v[52:55], v[76:79], v[112:127]
    s_waitcnt vmcnt(14)
    s_barrier
    ds_read_b128 v[52:55], v19
    ds_read_b64_tr_b16 v[68:69], v20 offset:9216
    ds_read_b64_tr_b16 v[70:71], v20 offset:9984
    ds_read_b64_tr_b16 v[72:73], v20 offset:9280
    ds_read_b64_tr_b16 v[74:75], v20 offset:10048
    ds_read_b64_tr_b16 v[76:77], v20 offset:9344
    ds_read_b64_tr_b16 v[78:79], v20 offset:10112
    s_waitcnt lgkmcnt(7)
    v_mfma_f32_32x32x16_bf16 v[80:95], v[48:51], v[56:59], v[80:95]
    s_add_u32 s45, s55, 5
    s_and_b32 s45, s45, 7
    s_lshl_b32 s45, s45, 7
    s_add_u32 m0, s48, 0
    s_nop 0
    buffer_load_dwordx4 v8, s[20:23], s45 offen lds
    v_mfma_f32_32x32x16_bf16 v[96:111], v[48:51], v[60:63], v[96:111]
    s_add_u32 s45, s55, 5
    s_and_b32 s45, s45, 7
    s_lshl_b32 s45, s45, 7
    s_add_u32 m0, s48, 1024
    s_nop 0
    buffer_load_dwordx4 v9, s[20:23], s45 offen lds
    v_mfma_f32_32x32x16_bf16 v[112:127], v[48:51], v[64:67], v[112:127]
    v_add_u32 v16, 28672, v16
    v_add_u32 v17, 28672, v17
    v_add_u32 v18, 28672, v18
    v_add_u32 v19, 28672, v19
    v_add_u32 v20, 28672, v20
    ds_read_b128 v[48:51], v16
    ds_read_b64_tr_b16 v[56:57], v20 offset:0
    ds_read_b64_tr_b16 v[58:59], v20 offset:768
    ds_read_b64_tr_b16 v[60:61], v20 offset:64
    ds_read_b64_tr_b16 v[62:63], v20 offset:832
    ds_read_b64_tr_b16 v[64:65], v20 offset:128
    ds_read_b64_tr_b16 v[66:67], v20 offset:896
    s_waitcnt lgkmcnt(7)
    v_mfma_f32_32x32x16_bf16 v[80:95], v[52:55], v[68:71], v[80:95]
    s_add_u32 s45, s55, 5
    s_and_b32 s45, s45, 7
    s_lshl_b32 s45, s45, 7
    s_add_u32 m0, s48, 2048
    s_nop 0
    buffer_load_dwordx4 v10, s[20:23], s45 offen lds
    v_mfma_f32_32x32x16_bf16 v[96:111], v[52:55], v[72:75], v[96:111]
    s_add_u32 s45, s55, 5
    s_and_b32 s45, s45, 7
    s_lshl_b32 s45, s45, 7
    s_add_u32 m0, s48, 3072
    s_nop 0
    buffer_load_dwordx4 v11, s[20:23], s45 offen lds
    v_mfma_f32_32x32x16_bf16 v[112:127], v[52:55], v[76:79], v[112:127]
    ds_read_b128 v[52:55], v17
    ds_read_b64_tr_b16 v[68:69], v20 offset:3072
    ds_read_b64_tr_b16 v[70:71], v20 offset:3840
    ds_read_b64_tr_b16 v[72:73], v20 offset:3136
    ds_read_b64_tr_b16 v[74:75], v20 offset:3904
    ds_read_b64_tr_b16 v[76:77], v20 offset:3200
    ds_read_b64_tr_b16 v[78:79], v20 offset:3968
    s_waitcnt lgkmcnt(7)
    v_mfma_f32_32x32x16_bf16 v[80:95], v[48:51], v[56:59], v[80:95]
    s_add_u32 s45, s55, 5
    s_and_b32 s45, s45, 7
    s_mul_i32 s45, s45, 196608
    s_add_u32 m0, s49, 0
    s_nop 0
    buffer_load_dwordx4 v12, s[24:27], s45 offen lds
    v_mfma_f32_32x32x16_bf16 v[96:111], v[48:51], v[60:63], v[96:111]
    s_add_u32 s45, s55, 5
    s_and_b32 s45, s45, 7
    s_mul_i32 s45, s45, 196608
    s_add_u32 m0, s49, 1024
    s_nop 0
    buffer_load_dwordx4 v13, s[24:27], s45 offen lds
    v_mfma_f32_32x32x16_bf16 v[112:127], v[48:51], v[64:67], v[112:127]
    ds_read_b128 v[48:51], v18
    ds_read_b64_tr_b16 v[56:57], v20 offset:6144
    ds_read_b64_tr_b16 v[58:59], v20 offset:6912
    ds_read_b64_tr_b16 v[60:61], v20 offset:6208
    ds_read_b64_tr_b16 v[62:63], v20 offset:6976
    ds_read_b64_tr_b16 v[64:65], v20 offset:6272
    ds_read_b64_tr_b16 v[66:67], v20 offset:7040
    s_waitcnt lgkmcnt(7)
    v_mfma_f32_32x32x16_bf16 v[80:95], v[52:55], v[68:71], v[80:95]
    s_add_u32 s45, s55, 5
    s_and_b32 s45, s45, 7
    s_mul_i32 s45, s45, 196608
    s_add_u32 m0, s49, 2048
    s_nop 0
    buffer_load_dwordx4 v14, s[24:27], s45 offen lds
    v_mfma_f32_32x32x16_bf16 v[96:111], v[52:55], v[72:75], v[96:111]
    v_mfma_f32_32x32x16_bf16 v[112:127], v[52:55], v[76:79], v[112:127]
    s_waitcnt vmcnt(14)
    s_barrier
    ds_read_b128 v[52:55], v19
    ds_read_b64_tr_b16 v[68:69], v20 offset:9216
    ds_read_b64_tr_b16 v[70:71], v20 offset:9984
    ds_read_b64_tr_b16 v[72:73], v20 offset:9280
    ds_read_b64_tr_b16 v[74:75], v20 offset:10048
    ds_read_b64_tr_b16 v[76:77], v20 offset:9344
    ds_read_b64_tr_b16 v[78:79], v20 offset:10112
    s_waitcnt lgkmcnt(7)
    v_mfma_f32_32x32x16_bf16 v[80:95], v[48:51], v[56:59], v[80:95]
    s_add_u32 s45, s55, 6
    s_and_b32 s45, s45, 7
    s_lshl_b32 s45, s45, 7
    s_add_u32 m0, s48, 28672
    s_nop 0
    buffer_load_dwordx4 v8, s[20:23], s45 offen lds
    v_mfma_f32_32x32x16_bf16 v[96:111], v[48:51], v[60:63], v[96:111]
    s_add_u32 s45, s55, 6
    s_and_b32 s45, s45, 7
    s_lshl_b32 s45, s45, 7
    s_add_u32 m0, s48, 29696
    s_nop 0
    buffer_load_dwordx4 v9, s[20:23], s45 offen lds
    v_mfma_f32_32x32x16_bf16 v[112:127], v[48:51], v[64:67], v[112:127]
    v_add_u32 v16, 28672, v16
    v_add_u32 v17, 28672, v17
    v_add_u32 v18, 28672, v18
    v_add_u32 v19, 28672, v19
    v_add_u32 v20, 28672, v20
    ds_read_b128 v[48:51], v16
    ds_read_b64_tr_b16 v[56:57], v20 offset:0
    ds_read_b64_tr_b16 v[58:59], v20 offset:768
    ds_read_b64_tr_b16 v[60:61], v20 offset:64
    ds_read_b64_tr_b16 v[62:63], v20 offset:832
    ds_read_b64_tr_b16 v[64:65], v20 offset:128
    ds_read_b64_tr_b16 v[66:67], v20 offset:896
    s_waitcnt lgkmcnt(7)
    v_mfma_f32_32x32x16_bf16 v[80:95], v[52:55], v[68:71], v[80:95]
    s_add_u32 s45, s55, 6
    s_and_b32 s45, s45, 7
    s_lshl_b32 s45, s45, 7
    s_add_u32 m0, s48, 30720
    s_nop 0
    buffer_load_dwordx4 v10, s[20:23], s45 offen lds
    v_mfma_f32_32x32x16_bf16 v[96:111], v[52:55], v[72:75], v[96:111]
    s_add_u32 s45, s55, 6
    s_and_b32 s45, s45, 7
    s_lshl_b32 s45, s45, 7
    s_add_u32 m0, s48, 31744
    s_nop 0
    buffer_load_dwordx4 v11, s[20:23], s45 offen lds
    v_mfma_f32_32x32x16_bf16 v[112:127], v[52:55], v[76:79], v[112:127]
    ds_read_b128 v[52:55], v17
    ds_read_b64_tr_b16 v[68:69], v20 offset:3072
    ds_read_b64_tr_b16 v[70:71], v20 offset:3840
    ds_read_b64_tr_b16 v[72:73], v20 offset:3136
    ds_read_b64_tr_b16 v[74:75], v20 offset:3904
    ds_read_b64_tr_b16 v[76:77], v20 offset:3200
    ds_read_b64_tr_b16 v[78:79], v20 offset:3968
    s_waitcnt lgkmcnt(7)
    v_mfma_f32_32x32x16_bf16 v[80:95], v[48:51], v[56:59], v[80:95]
    s_add_u32 s45, s55, 6
    s_and_b32 s45, s45, 7
    s_mul_i32 s45, s45, 196608
    s_add_u32 m0, s49, 28672
    s_nop 0
    buffer_load_dwordx4 v12, s[24:27], s45 offen lds
    v_mfma_f32_32x32x16_bf16 v[96:111], v[48:51], v[60:63], v[96:111]
    s_add_u32 s45, s55, 6
    s_and_b32 s45, s45, 7
    s_mul_i32 s45, s45, 196608
    s_add_u32 m0, s49, 29696
    s_nop 0
    buffer_load_dwordx4 v13, s[24:27], s45 offen lds
    v_mfma_f32_32x32x16_bf16 v[112:127], v[48:51], v[64:67], v[112:127]
    ds_read_b128 v[48:51], v18
    ds_read_b64_tr_b16 v[56:57], v20 offset:6144
    ds_read_b64_tr_b16 v[58:59], v20 offset:6912
    ds_read_b64_tr_b16 v[60:61], v20 offset:6208
    ds_read_b64_tr_b16 v[62:63], v20 offset:6976
    ds_read_b64_tr_b16 v[64:65], v20 offset:6272
    ds_read_b64_tr_b16 v[66:67], v20 offset:7040
    s_waitcnt lgkmcnt(7)
    v_mfma_f32_32x32x16_bf16 v[80:95], v[52:55], v[68:71], v[80:95]
    s_add_u32 s45, s55, 6
    s_and_b32 s45, s45, 7
    s_mul_i32 s45, s45, 196608
    s_add_u32 m0, s49, 30720
    s_nop 0
    buffer_load_dwordx4 v14, s[24:27], s45 offen lds
    v_mfma_f32_32x32x16_bf16 v[96:111], v[52:55], v[72:75], v[96:111]
    v_mfma_f32_32x32x16_bf16 v[112:127], v[52:55], v[76:79], v[112:127]
    s_waitcnt vmcnt(14)
    s_barrier
    ds_read_b128 v[52:55], v19
    ds_read_b64_tr_b16 v[68:69], v20 offset:9216
    ds_read_b64_tr_b16 v[70:71], v20 offset:9984
    ds_read_b64_tr_b16 v[72:73], v20 offset:9280
    ds_read_b64_tr_b16 v[74:75], v20 offset:10048
    ds_read_b64_tr_b16 v[76:77], v20 offset:9344
    ds_read_b64_tr_b16 v[78:79], v20 offset:10112
    s_waitcnt lgkmcnt(7)
    v_mfma_f32_32x32x16_bf16 v[80:95], v[48:51], v[56:59], v[80:95]
    s_add_u32 s45, s55, 7
    s_and_b32 s45, s45, 7
    s_lshl_b32 s45, s45, 7
    s_add_u32 m0, s48, 57344
    s_nop 0
    buffer_load_dwordx4 v8, s[20:23], s45 offen lds
    v_mfma_f32_32x32x16_bf16 v[96:111], v[48:51], v[60:63], v[96:111]
    s_add_u32 s45, s55, 7
    s_and_b32 s45, s45, 7
    s_lshl_b32 s45, s45, 7
    s_add_u32 m0, s48, 58368
    s_nop 0
    buffer_load_dwordx4 v9, s[20:23], s45 offen lds
    v_mfma_f32_32x32x16_bf16 v[112:127], v[48:51], v[64:67], v[112:127]
    v_add_u32 v16, 28672, v16
    v_add_u32 v17, 28672, v17
    v_add_u32 v18, 28672, v18
    v_add_u32 v19, 28672, v19
    v_add_u32 v20, 28672, v20
    ds_read_b128 v[48:51], v16
    ds_read_b64_tr_b16 v[56:57], v20 offset:0
    ds_read_b64_tr_b16 v[58:59], v20 offset:768
    ds_read_b64_tr_b16 v[60:61], v20 offset:64
    ds_read_b64_tr_b16 v[62:63], v20 offset:832
    ds_read_b64_tr_b16 v[64:65], v20 offset:128
    ds_read_b64_tr_b16 v[66:67], v20 offset:896
    s_waitcnt lgkmcnt(7)
    v_mfma_f32_32x32x16_bf16 v[80:95], v[52:55], v[68:71], v[80:95]
    s_add_u32 s45, s55, 7
    s_and_b32 s45, s45, 7
    s_lshl_b32 s45, s45, 7
    s_add_u32 m0, s48, 59392
    s_nop 0
    buffer_load_dwordx4 v10, s[20:23], s45 offen lds
    v_mfma_f32_32x32x16_bf16 v[96:111], v[52:55], v[72:75], v[96:111]
    s_add_u32 s45, s55, 7
    s_and_b32 s45, s45, 7
    s_lshl_b32 s45, s45, 7
    s_add_u32 m0, s48, 60416
    s_nop 0
    buffer_load_dwordx4 v11, s[20:23], s45 offen lds
    v_mfma_f32_32x32x16_bf16 v[112:127], v[52:55], v[76:79], v[112:127]
    ds_read_b128 v[52:55], v17
    ds_read_b64_tr_b16 v[68:69], v20 offset:3072
    ds_read_b64_tr_b16 v[70:71], v20 offset:3840
    ds_read_b64_tr_b16 v[72:73], v20 offset:3136
    ds_read_b64_tr_b16 v[74:75], v20 offset:3904
    ds_read_b64_tr_b16 v[76:77], v20 offset:3200
    ds_read_b64_tr_b16 v[78:79], v20 offset:3968
    s_waitcnt lgkmcnt(7)
    v_mfma_f32_32x32x16_bf16 v[80:95], v[48:51], v[56:59], v[80:95]
    s_add_u32 s45, s55, 7
    s_and_b32 s45, s45, 7
    s_mul_i32 s45, s45, 196608
    s_add_u32 m0, s49, 57344
    s_nop 0
    buffer_load_dwordx4 v12, s[24:27], s45 offen lds
    v_mfma_f32_32x32x16_bf16 v[96:111], v[48:51], v[60:63], v[96:111]
    s_add_u32 s45, s55, 7
    s_and_b32 s45, s45, 7
    s_mul_i32 s45, s45, 196608
    s_add_u32 m0, s49, 58368
    s_nop 0
    buffer_load_dwordx4 v13, s[24:27], s45 offen lds
    v_mfma_f32_32x32x16_bf16 v[112:127], v[48:51], v[64:67], v[112:127]
    ds_read_b128 v[48:51], v18
    ds_read_b64_tr_b16 v[56:57], v20 offset:6144
    ds_read_b64_tr_b16 v[58:59], v20 offset:6912
    ds_read_b64_tr_b16 v[60:61], v20 offset:6208
    ds_read_b64_tr_b16 v[62:63], v20 offset:6976
    ds_read_b64_tr_b16 v[64:65], v20 offset:6272
    ds_read_b64_tr_b16 v[66:67], v20 offset:7040
    s_waitcnt lgkmcnt(7)
    v_mfma_f32_32x32x16_bf16 v[80:95], v[52:55], v[68:71], v[80:95]
    s_add_u32 s45, s55, 7
    s_and_b32 s45, s45, 7
    s_mul_i32 s45, s45, 196608
    s_add_u32 m0, s49, 59392
    s_nop 0
    buffer_load_dwordx4 v14, s[24:27], s45 offen lds
    v_mfma_f32_32x32x16_bf16 v[96:111], v[52:55], v[72:75], v[96:111]
    v_mfma_f32_32x32x16_bf16 v[112:127], v[52:55], v[76:79], v[112:127]
    s_waitcnt vmcnt(14)
    s_barrier
    ds_read_b128 v[52:55], v19
    ds_read_b64_tr_b16 v[68:69], v20 offset:9216
    ds_read_b64_tr_b16 v[70:71], v20 offset:9984
    ds_read_b64_tr_b16 v[72:73], v20 offset:9280
    ds_read_b64_tr_b16 v[74:75], v20 offset:10048
    ds_read_b64_tr_b16 v[76:77], v20 offset:9344
    ds_read_b64_tr_b16 v[78:79], v20 offset:10112
    s_waitcnt lgkmcnt(7)
    v_mfma_f32_32x32x16_bf16 v[80:95], v[48:51], v[56:59], v[80:95]
    v_mfma_f32_32x32x16_bf16 v[96:111], v[48:51], v[60:63], v[96:111]
    v_mfma_f32_32x32x16_bf16 v[112:127], v[48:51], v[64:67], v[112:127]
    v_subrev_u32 v16, 114688, v16
    v_subrev_u32 v17, 114688, v17
    v_subrev_u32 v18, 114688, v18
    v_subrev_u32 v19, 114688, v19
    v_subrev_u32 v20, 114688, v20
    ds_read_b128 v[48:51], v16
    ds_read_b64_tr_b16 v[56:57], v20 offset:0
    ds_read_b64_tr_b16 v[58:59], v20 offset:768
    ds_read_b64_tr_b16 v[60:61], v20 offset:64
    ds_read_b64_tr_b16 v[62:63], v20 offset:832
    ds_read_b64_tr_b16 v[64:65], v20 offset:128
    ds_read_b64_tr_b16 v[66:67], v20 offset:896
    s_waitcnt lgkmcnt(7)
    v_mfma_f32_32x32x16_bf16 v[80:95], v[52:55], v[68:71], v[80:95]
    v_mfma_f32_32x32x16_bf16 v[96:111], v[52:55], v[72:75], v[96:111]
    v_mfma_f32_32x32x16_bf16 v[112:127], v[52:55], v[76:79], v[112:127]
    ds_read_b128 v[52:55], v17
    ds_read_b64_tr_b16 v[68:69], v20 offset:3072
    ds_read_b64_tr_b16 v[70:71], v20 offset:3840
    ds_read_b64_tr_b16 v[72:73], v20 offset:3136
    ds_read_b64_tr_b16 v[74:75], v20 offset:3904
    ds_read_b64_tr_b16 v[76:77], v20 offset:3200
    ds_read_b64_tr_b16 v[78:79], v20 offset:3968
    s_waitcnt lgkmcnt(7)
    v_mfma_f32_32x32x16_bf16 v[80:95], v[48:51], v[56:59], v[80:95]
    v_mfma_f32_32x32x16_bf16 v[96:111], v[48:51], v[60:63], v[96:111]
    v_mfma_f32_32x32x16_bf16 v[112:127], v[48:51], v[64:67], v[112:127]
    ds_read_b128 v[48:51], v18
    ds_read_b64_tr_b16 v[56:57], v20 offset:6144
    ds_read_b64_tr_b16 v[58:59], v20 offset:6912
    ds_read_b64_tr_b16 v[60:61], v20 offset:6208
    ds_read_b64_tr_b16 v[62:63], v20 offset:6976
    ds_read_b64_tr_b16 v[64:65], v20 offset:6272
    ds_read_b64_tr_b16 v[66:67], v20 offset:7040
    s_waitcnt lgkmcnt(7)
    v_mfma_f32_32x32x16_bf16 v[80:95], v[52:55], v[68:71], v[80:95]
    v_mfma_f32_32x32x16_bf16 v[96:111], v[52:55], v[72:75], v[96:111]
    v_mfma_f32_32x32x16_bf16 v[112:127], v[52:55], v[76:79], v[112:127]
    s_waitcnt vmcnt(7)
    s_barrier
    ds_read_b128 v[52:55], v19
    ds_read_b64_tr_b16 v[68:69], v20 offset:9216
    ds_read_b64_tr_b16 v[70:71], v20 offset:9984
    ds_read_b64_tr_b16 v[72:73], v20 offset:9280
    ds_read_b64_tr_b16 v[74:75], v20 offset:10048
    ds_read_b64_tr_b16 v[76:77], v20 offset:9344
    ds_read_b64_tr_b16 v[78:79], v20 offset:10112
    s_waitcnt lgkmcnt(7)
    v_mfma_f32_32x32x16_bf16 v[80:95], v[48:51], v[56:59], v[80:95]
    v_mfma_f32_32x32x16_bf16 v[96:111], v[48:51], v[60:63], v[96:111]
    v_mfma_f32_32x32x16_bf16 v[112:127], v[48:51], v[64:67], v[112:127]
    v_add_u32 v16, 28672, v16
    v_add_u32 v17, 28672, v17
    v_add_u32 v18, 28672, v18
    v_add_u32 v19, 28672, v19
    v_add_u32 v20, 28672, v20
    ds_read_b128 v[48:51], v16
    ds_read_b64_tr_b16 v[56:57], v20 offset:0
    ds_read_b64_tr_b16 v[58:59], v20 offset:768
    ds_read_b64_tr_b16 v[60:61], v20 offset:64
    ds_read_b64_tr_b16 v[62:63], v20 offset:832
    ds_read_b64_tr_b16 v[64:65], v20 offset:128
    ds_read_b64_tr_b16 v[66:67], v20 offset:896
    s_waitcnt lgkmcnt(7)
    v_mfma_f32_32x32x16_bf16 v[80:95], v[52:55], v[68:71], v[80:95]
    v_mfma_f32_32x32x16_bf16 v[96:111], v[52:55], v[72:75], v[96:111]
    v_mfma_f32_32x32x16_bf16 v[112:127], v[52:55], v[76:79], v[112:127]
    ds_read_b128 v[52:55], v17
    ds_read_b64_tr_b16 v[68:69], v20 offset:3072
    ds_read_b64_tr_b16 v[70:71], v20 offset:3840
    ds_read_b64_tr_b16 v[72:73], v20 offset:3136
    ds_read_b64_tr_b16 v[74:75], v20 offset:3904
    ds_read_b64_tr_b16 v[76:77], v20 offset:3200
    ds_read_b64_tr_b16 v[78:79], v20 offset:3968
    s_waitcnt lgkmcnt(7)
    v_mfma_f32_32x32x16_bf16 v[80:95], v[48:51], v[56:59], v[80:95]
    v_mfma_f32_32x32x16_bf16 v[96:111], v[48:51], v[60:63], v[96:111]
    v_mfma_f32_32x32x16_bf16 v[112:127], v[48:51], v[64:67], v[112:127]
    ds_read_b128 v[48:51], v18
    ds_read_b64_tr_b16 v[56:57], v20 offset:6144
    ds_read_b64_tr_b16 v[58:59], v20 offset:6912
    ds_read_b64_tr_b16 v[60:61], v20 offset:6208
    ds_read_b64_tr_b16 v[62:63], v20 offset:6976
    ds_read_b64_tr_b16 v[64:65], v20 offset:6272
    ds_read_b64_tr_b16 v[66:67], v20 offset:7040
    s_waitcnt lgkmcnt(7)
    v_mfma_f32_32x32x16_bf16 v[80:95], v[52:55], v[68:71], v[80:95]
    v_mfma_f32_32x32x16_bf16 v[96:111], v[52:55], v[72:75], v[96:111]
    v_mfma_f32_32x32x16_bf16 v[112:127], v[52:55], v[76:79], v[112:127]
    s_waitcnt vmcnt(0)
    s_barrier
    ds_read_b128 v[52:55], v19
    ds_read_b64_tr_b16 v[68:69], v20 offset:9216
    ds_read_b64_tr_b16 v[70:71], v20 offset:9984
    ds_read_b64_tr_b16 v[72:73], v20 offset:9280
    ds_read_b64_tr_b16 v[74:75], v20 offset:10048
    ds_read_b64_tr_b16 v[76:77], v20 offset:9344
    ds_read_b64_tr_b16 v[78:79], v20 offset:10112
    s_waitcnt lgkmcnt(7)
    v_mfma_f32_32x32x16_bf16 v[80:95], v[48:51], v[56:59], v[80:95]
    v_mfma_f32_32x32x16_bf16 v[96:111], v[48:51], v[60:63], v[96:111]
    v_mfma_f32_32x32x16_bf16 v[112:127], v[48:51], v[64:67], v[112:127]
    v_add_u32 v16, 28672, v16
    v_add_u32 v17, 28672, v17
    v_add_u32 v18, 28672, v18
    v_add_u32 v19, 28672, v19
    v_add_u32 v20, 28672, v20
    ds_read_b128 v[48:51], v16
    ds_read_b64_tr_b16 v[56:57], v20 offset:0
    ds_read_b64_tr_b16 v[58:59], v20 offset:768
    ds_read_b64_tr_b16 v[60:61], v20 offset:64
    ds_read_b64_tr_b16 v[62:63], v20 offset:832
    ds_read_b64_tr_b16 v[64:65], v20 offset:128
    ds_read_b64_tr_b16 v[66:67], v20 offset:896
    s_waitcnt lgkmcnt(7)
    v_mfma_f32_32x32x16_bf16 v[80:95], v[52:55], v[68:71], v[80:95]
    v_mfma_f32_32x32x16_bf16 v[96:111], v[52:55], v[72:75], v[96:111]
    v_mfma_f32_32x32x16_bf16 v[112:127], v[52:55], v[76:79], v[112:127]
    ds_read_b128 v[52:55], v17
    ds_read_b64_tr_b16 v[68:69], v20 offset:3072
    ds_read_b64_tr_b16 v[70:71], v20 offset:3840
    ds_read_b64_tr_b16 v[72:73], v20 offset:3136
    ds_read_b64_tr_b16 v[74:75], v20 offset:3904
    ds_read_b64_tr_b16 v[76:77], v20 offset:3200
    ds_read_b64_tr_b16 v[78:79], v20 offset:3968
    s_waitcnt lgkmcnt(7)
    v_mfma_f32_32x32x16_bf16 v[80:95], v[48:51], v[56:59], v[80:95]
    v_mfma_f32_32x32x16_bf16 v[96:111], v[48:51], v[60:63], v[96:111]
    v_mfma_f32_32x32x16_bf16 v[112:127], v[48:51], v[64:67], v[112:127]
    ds_read_b128 v[48:51], v18
    ds_read_b64_tr_b16 v[56:57], v20 offset:6144
    ds_read_b64_tr_b16 v[58:59], v20 offset:6912
    ds_read_b64_tr_b16 v[60:61], v20 offset:6208
    ds_read_b64_tr_b16 v[62:63], v20 offset:6976
    ds_read_b64_tr_b16 v[64:65], v20 offset:6272
    ds_read_b64_tr_b16 v[66:67], v20 offset:7040
    s_waitcnt lgkmcnt(7)
    v_mfma_f32_32x32x16_bf16 v[80:95], v[52:55], v[68:71], v[80:95]
    v_mfma_f32_32x32x16_bf16 v[96:111], v[52:55], v[72:75], v[96:111]
    v_mfma_f32_32x32x16_bf16 v[112:127], v[52:55], v[76:79], v[112:127]
    ds_read_b128 v[52:55], v19
    ds_read_b64_tr_b16 v[68:69], v20 offset:9216
    ds_read_b64_tr_b16 v[70:71], v20 offset:9984
    ds_read_b64_tr_b16 v[72:73], v20 offset:9280
    ds_read_b64_tr_b16 v[74:75], v20 offset:10048
    ds_read_b64_tr_b16 v[76:77], v20 offset:9344
    ds_read_b64_tr_b16 v[78:79], v20 offset:10112
    s_waitcnt lgkmcnt(7)
    v_mfma_f32_32x32x16_bf16 v[80:95], v[48:51], v[56:59], v[80:95]
    v_mfma_f32_32x32x16_bf16 v[96:111], v[48:51], v[60:63], v[96:111]
    v_mfma_f32_32x32x16_bf16 v[112:127], v[48:51], v[64:67], v[112:127]
    s_waitcnt lgkmcnt(0)
    v_mfma_f32_32x32x16_bf16 v[80:95], v[52:55], v[68:71], v[80:95]
    v_mfma_f32_32x32x16_bf16 v[96:111], v[52:55], v[72:75], v[96:111]
    v_mfma_f32_32x32x16_bf16 v[112:127], v[52:55], v[76:79], v[112:127]
    s_branch K1_EPI
K1_EPI:
    v_and_b32 v2, 31, v1
    v_lshrrev_b32 v3, 5, v1
    s_nop 15
    s_add_u32 s45, s51, 0
    s_lshr_b32 s47, s45, 9
    s_and_b32 s45, s45, 511
    s_lshr_b32 s45, s45, 4
    s_cmp_eq_u32 s47, 1
    s_cbranch_scc1 K1_EK0
    s_cmp_eq_u32 s47, 2
    s_cbranch_scc1 K1_EV0
    v_mul_f32 v80, 0x3eb8aa3b, v80
    v_mul_f32 v81, 0x3eb8aa3b, v81
    v_mul_f32 v82, 0x3eb8aa3b, v82
    v_mul_f32 v83, 0x3eb8aa3b, v83
    v_mul_f32 v84, 0x3eb8aa3b, v84
    v_mul_f32 v85, 0x3eb8aa3b, v85
    v_mul_f32 v86, 0x3eb8aa3b, v86
    v_mul_f32 v87, 0x3eb8aa3b, v87
    v_mul_f32 v88, 0x3eb8aa3b, v88
    v_mul_f32 v89, 0x3eb8aa3b, v89
    v_mul_f32 v90, 0x3eb8aa3b, v90
    v_mul_f32 v91, 0x3eb8aa3b, v91
    v_mul_f32 v92, 0x3eb8aa3b, v92
    v_mul_f32 v93, 0x3eb8aa3b, v93
    v_mul_f32 v94, 0x3eb8aa3b, v94
    v_mul_f32 v95, 0x3eb8aa3b, v95
    v_cvt_pk_bf16_f32 v48, v80, v81
    v_cvt_pk_bf16_f32 v49, v82, v83
    v_cvt_pk_bf16_f32 v50, v84, v85
    v_cvt_pk_bf16_f32 v51, v86, v87
    v_cvt_pk_bf16_f32 v52, v88, v89
    v_cvt_pk_bf16_f32 v53, v90, v91
    v_cvt_pk_bf16_f32 v54, v92, v93
    v_cvt_pk_bf16_f32 v55, v94, v95
    v_add_u32 v4, s53, v2
    v_lshlrev_b32 v4, 5, v4
    v_lshl_add_u32 v4, v3, 4, v4
    s_lshl_b32 s45, s45, 16
    s_add_u32 s45, s45, 0
    buffer_store_dwordx4 v[48:51], v4, s[28:31], s45 offen
    s_add_u32 s45, s45, 65536
    buffer_store_dwordx4 v[52:55], v4, s[28:31], s45 offen
    s_branch K1_EN0
K1_EK0:
    v_cvt_pk_bf16_f32 v48, v80, v81
    v_cvt_pk_bf16_f32 v49, v82, v83
    v_cvt_pk_bf16_f32 v50, v84, v85
    v_cvt_pk_bf16_f32 v51, v86, v87
    v_cvt_pk_bf16_f32 v52, v88, v89
    v_cvt_pk_bf16_f32 v53, v90, v91
    v_cvt_pk_bf16_f32 v54, v92, v93
    v_cvt_pk_bf16_f32 v55, v94, v95
    v_lshlrev_b32 v4, 4, v2
    v_lshl_add_u32 v4, v3, 9, v4
    s_lshl_b32 s45, s45, 16
    s_lshl_b32 s47, s53, 5
    s_add_u32 s45, s45, s47
    s_add_u32 s45, s45, 2097152
    buffer_store_dwordx4 v[48:51], v4, s[28:31], s45 offen
    s_add_u32 s45, s45, 65536
    buffer_store_dwordx4 v[52:55], v4, s[28:31], s45 offen
    s_branch K1_EN0
K1_EV0:
    v_cvt_pk_bf16_f32 v48, v80, v81
    v_cvt_pk_bf16_f32 v49, v82, v83
    v_cvt_pk_bf16_f32 v50, v84, v85
    v_cvt_pk_bf16_f32 v51, v86, v87
    v_cvt_pk_bf16_f32 v52, v88, v89
    v_cvt_pk_bf16_f32 v53, v90, v91
    v_cvt_pk_bf16_f32 v54, v92, v93
    v_cvt_pk_bf16_f32 v55, v94, v95
    v_and_b32 v4, 15, v2
    v_lshlrev_b32 v4, 4, v4
    v_lshl_add_u32 v4, v3, 8, v4
    v_lshrrev_b32 v5, 4, v2
    v_lshl_add_u32 v4, v5, 16, v4
    s_lshl_b32 s45, s45, 16
    s_lshl_b32 s47, s53, 5
    s_add_u32 s45, s45, s47
    s_add_u32 s45, s45, 4194304
    buffer_store_dwordx4 v[48:51], v4, s[28:31], s45 offen
    buffer_store_dwordx4 v[52:55], v4, s[28:31], s45 offen offset:512
K1_EN0:
    s_nop 1
    s_add_u32 s45, s51, 32
    s_lshr_b32 s47, s45, 9
    s_and_b32 s45, s45, 511
    s_lshr_b32 s45, s45, 4
    s_cmp_eq_u32 s47, 1
    s_cbranch_scc1 K1_EK1
    s_cmp_eq_u32 s47, 2
    s_cbranch_scc1 K1_EV1
    v_mul_f32 v96, 0x3eb8aa3b, v96
    v_mul_f32 v97, 0x3eb8aa3b, v97
    v_mul_f32 v98, 0x3eb8aa3b, v98
    v_mul_f32 v99, 0x3eb8aa3b, v99
    v_mul_f32 v100, 0x3eb8aa3b, v100
    v_mul_f32 v101, 0x3eb8aa3b, v101
    v_mul_f32 v102, 0x3eb8aa3b, v102
    v_mul_f32 v103, 0x3eb8aa3b, v103
    v_mul_f32 v104, 0x3eb8aa3b, v104
    v_mul_f32 v105, 0x3eb8aa3b, v105
    v_mul_f32 v106, 0x3eb8aa3b, v106
    v_mul_f32 v107, 0x3eb8aa3b, v107
    v_mul_f32 v108, 0x3eb8aa3b, v108
    v_mul_f32 v109, 0x3eb8aa3b, v109
    v_mul_f32 v110, 0x3eb8aa3b, v110
    v_mul_f32 v111, 0x3eb8aa3b, v111
    v_cvt_pk_bf16_f32 v48, v96, v97
    v_cvt_pk_bf16_f32 v49, v98, v99
    v_cvt_pk_bf16_f32 v50, v100, v101
    v_cvt_pk_bf16_f32 v51, v102, v103
    v_cvt_pk_bf16_f32 v52, v104, v105
    v_cvt_pk_bf16_f32 v53, v106, v107
    v_cvt_pk_bf16_f32 v54, v108, v109
    v_cvt_pk_bf16_f32 v55, v110, v111
    v_add_u32 v4, s53, v2
    v_lshlrev_b32 v4, 5, v4
    v_lshl_add_u32 v4, v3, 4, v4
    s_lshl_b32 s45, s45, 16
    s_add_u32 s45, s45, 0
    buffer_store_dwordx4 v[48:51], v4, s[28:31], s45 offen
    s_add_u32 s45, s45, 65536
    buffer_store_dwordx4 v[52:55], v4, s[28:31], s45 offen
    s_branch K1_EN1
K1_EK1:
    v_cvt_pk_bf16_f32 v48, v96, v97
    v_cvt_pk_bf16_f32 v49, v98, v99
    v_cvt_pk_bf16_f32 v50, v100, v101
    v_cvt_pk_bf16_f32 v51, v102, v103
    v_cvt_pk_bf16_f32 v52, v104, v105
    v_cvt_pk_bf16_f32 v53, v106, v107
    v_cvt_pk_bf16_f32 v54, v108, v109
    v_cvt_pk_bf16_f32 v55, v110, v111
    v_lshlrev_b32 v4, 4, v2
    v_lshl_add_u32 v4, v3, 9, v4
    s_lshl_b32 s45, s45, 16
    s_lshl_b32 s47, s53, 5
    s_add_u32 s45, s45, s47
    s_add_u32 s45, s45, 2097152
    buffer_store_dwordx4 v[48:51], v4, s[28:31], s45 offen
    s_add_u32 s45, s45, 65536
    buffer_store_dwordx4 v[52:55], v4, s[28:31], s45 offen
    s_branch K1_EN1
K1_EV1:
    v_cvt_pk_bf16_f32 v48, v96, v97
    v_cvt_pk_bf16_f32 v49, v98, v99
    v_cvt_pk_bf16_f32 v50, v100, v101
    v_cvt_pk_bf16_f32 v51, v102, v103
    v_cvt_pk_bf16_f32 v52, v104, v105
    v_cvt_pk_bf16_f32 v53, v106, v107
    v_cvt_pk_bf16_f32 v54, v108, v109
    v_cvt_pk_bf16_f32 v55, v110, v111
    v_and_b32 v4, 15, v2
    v_lshlrev_b32 v4, 4, v4
    v_lshl_add_u32 v4, v3, 8, v4
    v_lshrrev_b32 v5, 4, v2
    v_lshl_add_u32 v4, v5, 16, v4
    s_lshl_b32 s45, s45, 16
    s_lshl_b32 s47, s53, 5
    s_add_u32 s45, s45, s47
    s_add_u32 s45, s45, 4194304
    buffer_store_dwordx4 v[48:51], v4, s[28:31], s45 offen
    buffer_store_dwordx4 v[52:55], v4, s[28:31], s45 offen offset:512
K1_EN1:
    s_nop 1
    s_add_u32 s45, s51, 64
    s_lshr_b32 s47, s45, 9
    s_and_b32 s45, s45, 511
    s_lshr_b32 s45, s45, 4
    s_cmp_eq_u32 s47, 1
    s_cbranch_scc1 K1_EK2
    s_cmp_eq_u32 s47, 2
    s_cbranch_scc1 K1_EV2
    v_mul_f32 v112, 0x3eb8aa3b, v112
    v_mul_f32 v113, 0x3eb8aa3b, v113
    v_mul_f32 v114, 0x3eb8aa3b, v114
    v_mul_f32 v115, 0x3eb8aa3b, v115
    v_mul_f32 v116, 0x3eb8aa3b, v116
    v_mul_f32 v117, 0x3eb8aa3b, v117
    v_mul_f32 v118, 0x3eb8aa3b, v118
    v_mul_f32 v119, 0x3eb8aa3b, v119
    v_mul_f32 v120, 0x3eb8aa3b, v120
    v_mul_f32 v121, 0x3eb8aa3b, v121
    v_mul_f32 v122, 0x3eb8aa3b, v122
    v_mul_f32 v123, 0x3eb8aa3b, v123
    v_mul_f32 v124, 0x3eb8aa3b, v124
    v_mul_f32 v125, 0x3eb8aa3b, v125
    v_mul_f32 v126, 0x3eb8aa3b, v126
    v_mul_f32 v127, 0x3eb8aa3b, v127
    v_cvt_pk_bf16_f32 v48, v112, v113
    v_cvt_pk_bf16_f32 v49, v114, v115
    v_cvt_pk_bf16_f32 v50, v116, v117
    v_cvt_pk_bf16_f32 v51, v118, v119
    v_cvt_pk_bf16_f32 v52, v120, v121
    v_cvt_pk_bf16_f32 v53, v122, v123
    v_cvt_pk_bf16_f32 v54, v124, v125
    v_cvt_pk_bf16_f32 v55, v126, v127
    v_add_u32 v4, s53, v2
    v_lshlrev_b32 v4, 5, v4
    v_lshl_add_u32 v4, v3, 4, v4
    s_lshl_b32 s45, s45, 16
    s_add_u32 s45, s45, 0
    buffer_store_dwordx4 v[48:51], v4, s[28:31], s45 offen
    s_add_u32 s45, s45, 65536
    buffer_store_dwordx4 v[52:55], v4, s[28:31], s45 offen
    s_branch K1_EN2
K1_EK2:
    v_cvt_pk_bf16_f32 v48, v112, v113
    v_cvt_pk_bf16_f32 v49, v114, v115
    v_cvt_pk_bf16_f32 v50, v116, v117
    v_cvt_pk_bf16_f32 v51, v118, v119
    v_cvt_pk_bf16_f32 v52, v120, v121
    v_cvt_pk_bf16_f32 v53, v122, v123
    v_cvt_pk_bf16_f32 v54, v124, v125
    v_cvt_pk_bf16_f32 v55, v126, v127
    v_lshlrev_b32 v4, 4, v2
    v_lshl_add_u32 v4, v3, 9, v4
    s_lshl_b32 s45, s45, 16
    s_lshl_b32 s47, s53, 5
    s_add_u32 s45, s45, s47
    s_add_u32 s45, s45, 2097152
    buffer_store_dwordx4 v[48:51], v4, s[28:31], s45 offen
    s_add_u32 s45, s45, 65536
    buffer_store_dwordx4 v[52:55], v4, s[28:31], s45 offen
    s_branch K1_EN2
K1_EV2:
    v_cvt_pk_bf16_f32 v48, v112, v113
    v_cvt_pk_bf16_f32 v49, v114, v115
    v_cvt_pk_bf16_f32 v50, v116, v117
    v_cvt_pk_bf16_f32 v51, v118, v119
    v_cvt_pk_bf16_f32 v52, v120, v121
    v_cvt_pk_bf16_f32 v53, v122, v123
    v_cvt_pk_bf16_f32 v54, v124, v125
    v_cvt_pk_bf16_f32 v55, v126, v127
    v_and_b32 v4, 15, v2
    v_lshlrev_b32 v4, 4, v4
    v_lshl_add_u32 v4, v3, 8, v4
    v_lshrrev_b32 v5, 4, v2
    v_lshl_add_u32 v4, v5, 16, v4
    s_lshl_b32 s45, s45, 16
    s_lshl_b32 s47, s53, 5
    s_add_u32 s45, s45, s47
    s_add_u32 s45, s45, 4194304
    buffer_store_dwordx4 v[48:51], v4, s[28:31], s45 offen
    buffer_store_dwordx4 v[52:55], v4, s[28:31], s45 offen offset:512
K1_EN2:
    s_nop 1
    s_lshl_b32 s45, s2, 3
    s_lshl_b32 s46, s40, 1
    s_add_u32 s45, s45, s46
    s_lshl_b32 s45, s45, 2
    s_add_u32 s45, s45, 14680064
    v_lshlrev_b32 v2, 2, v1
    v_cmp_gt_u32 vcc, 2, v1
    s_and_saveexec_b64 s[64:65], vcc
    buffer_store_dword v22, v2, s[28:31], s45 offen
    s_mov_b64 exec, s[64:65]
K1_END:
    s_endpgm
.globl k2_attn_kernel
.p2align 8
.type k2_attn_kernel,@function
k2_attn_kernel:
    s_cmp_ge_u32 s2, 256
    s_cbranch_scc1 K2_END
    s_load_dwordx2 s[14:15], s[0:1], 80
    v_and_b32 v1, 63, v0
    v_lshrrev_b32 v2, 6, v0
    s_nop 0
    v_readfirstlane_b32 s40, v2
    s_and_b32 s42, s2, 7
    s_lshr_b32 s41, s2, 3
    s_load_dwordx2 s[4:5], s[0:1], 16
    s_load_dwordx2 s[6:7], s[0:1], 48
    s_waitcnt lgkmcnt(0)
    s_mov_b32 s20, s14
    s_and_b32 s21, s15, 0xffff
    s_mov_b32 s22, 18874368
    s_mov_b32 s23, 0x00020000
    s_cmp_ge_u32 s40, 8
    s_cbranch_scc1 K2_G
    s_mov_b32 s24, s4
    s_and_b32 s25, s5, 0xffff
    s_mov_b32 s26, 524288
    s_mov_b32 s27, 0x00020000
    s_mov_b32 s28, s6
    s_and_b32 s29, s7, 0xffff
    s_mov_b32 s30, 1409024
    s_mov_b32 s31, 0x00020000
    v_and_b32 v2, 31, v1
    v_lshrrev_b32 v3, 5, v1
    v_lshlrev_b32 v2, 5, v2
    v_lshl_add_u32 v2, v3, 4, v2
    s_lshl_b32 s43, s41, 11
    s_lshl_b32 s44, s42, 8
    s_add_u32 s43, s43, s44
    s_lshl_b32 s44, s40, 5
    s_add_u32 s43, s43, s44
    s_lshl_b32 s43, s43, 5
    s_add_u32 s43, s43, 0
    buffer_load_dwordx4 v[8:11], v2, s[20:23], s43 offen
    v_lshlrev_b32 v6, 4, v1
    s_lshl_b32 s44, s40, 10
    s_lshl_b32 s43, s41, 16
    s_add_u32 s43, s43, s44
    s_mov_b32 s48, s44
    s_add_u32 s49, s43, 2097152
    s_mov_b32 m0, s48
    s_add_u32 s50, s49, 2097152
    buffer_load_dwordx4 v6, s[20:23], s49 offen lds
    s_add_u32 m0, s48, 65536
    s_add_u32 s48, s48, 8192
    buffer_load_dwordx4 v6, s[20:23], s50 offen lds
    s_add_u32 s49, s49, 8192
    v_and_b32 v2, 31, v1
    v_cmp_eq_u32 vcc, 16, v2
    v_mov_b32 v3, 0x3f803f80
    s_nop 0
    v_cndmask_b32 v3, 0, v3, vcc
    v_mov_b32 v20, v3
    v_mov_b32 v21, v3
    v_mov_b32 v22, v3
    v_mov_b32 v23, v3
    v_mov_b32 v24, v3
    v_mov_b32 v25, v3
    v_mov_b32 v26, v3
    v_mov_b32 v27, v3
    v_mov_b32 v28, v3
    v_mov_b32 v29, v3
    v_mov_b32 v30, v3
    v_mov_b32 v31, v3
    v_mov_b32 v32, v3
    v_mov_b32 v33, v3
    v_mov_b32 v34, v3
    v_mov_b32 v35, v3
    s_mov_b32 s52, 0x0000ffff
    s_mov_b32 s53, 0x0000ffff
    s_mov_b32 s45, 0
    s_waitcnt vmcnt(0)
    s_barrier
    v_lshlrev_b32 v4, 4, v1
    ds_read_b128 v[12:15], v4
    s_waitcnt lgkmcnt(0)
    v_mfma_f32_32x32x16_bf16 v[48:63], v[12:15], v[8:11], 0
    s_nop 15
    v_max3_f32 v112, v48, v49, v50
    v_max3_f32 v112, v112, v51, v52
    v_max3_f32 v112, v112, v53, v54
    v_max3_f32 v112, v112, v55, v56
    v_max3_f32 v112, v112, v57, v58
    v_max3_f32 v112, v112, v59, v60
    v_max3_f32 v112, v112, v61, v62
    v_max_f32 v112, v112, v63
    v_mov_b32 v113, v112
    v_mov_b32 v114, v112
    s_nop 1
    v_permlane32_swap_b32 v113, v114
    s_nop 1
    v_max_f32 v112, v113, v114
K2_RUN:
    v_sub_f32 v80, 0, v112
    v_sub_f32 v81, 0, v112
    v_sub_f32 v82, 0, v112
    v_sub_f32 v83, 0, v112
    v_sub_f32 v84, 0, v112
    v_sub_f32 v85, 0, v112
    v_sub_f32 v86, 0, v112
    v_sub_f32 v87, 0, v112
    v_sub_f32 v88, 0, v112
    v_sub_f32 v89, 0, v112
    v_sub_f32 v90, 0, v112
    v_sub_f32 v91, 0, v112
    v_sub_f32 v92, 0, v112
    v_sub_f32 v93, 0, v112
    v_sub_f32 v94, 0, v112
    v_sub_f32 v95, 0, v112
    v_mov_b32 v96, 0
    v_mov_b32 v97, 0
    v_mov_b32 v98, 0
    v_mov_b32 v99, 0
    v_mov_b32 v100, 0
    v_mov_b32 v101, 0
    v_mov_b32 v102, 0
    v_mov_b32 v103, 0
    v_mov_b32 v104, 0
    v_mov_b32 v105, 0
    v_mov_b32 v106, 0
    v_mov_b32 v107, 0
    v_mov_b32 v108, 0
    v_mov_b32 v109, 0
    v_mov_b32 v110, 0
    v_mov_b32 v111, 0
    v_lshlrev_b32 v4, 4, v1
    v_and_b32 v2, 31, v1
    v_lshrrev_b32 v3, 5, v1
    v_lshlrev_b32 v2, 4, v2
    v_lshl_add_u32 v2, v3, 8, v2
    v_add_u32 v5, 65536, v2
    ds_read_b128 v[12:15], v4 offset:0
    ds_read_b128 v[16:19], v4 offset:1024
    s_mov_b64 exec, s[52:53]
    ds_read_b128 v[20:23], v5 offset:0
    ds_read_b128 v[24:27], v5 offset:512
    s_mov_b64 exec, -1
    s_waitcnt lgkmcnt(3)
    v_mfma_f32_32x32x16_bf16 v[48:63], v[12:15], v[8:11], v[80:95]
    v_mov_b32 v40, 0
    v_mov_b32 v41, 0
    v_mov_b32 v42, 0
    v_mov_b32 v43, 0
    s_cmp_lg_u32 s45, 0
    s_cbranch_scc1 K2_PASS1
    s_mov_b32 s46, 4294967293
.p2align 3
K2_LOOP0:
    s_mov_b32 m0, s48
    s_add_u32 s50, s49, 2097152
    buffer_load_dwordx4 v6, s[20:23], s49 offen lds
    s_add_u32 m0, s48, 65536
    s_add_u32 s48, s48, 8192
    buffer_load_dwordx4 v6, s[20:23], s50 offen lds
    s_add_u32 s49, s49, 8192
    s_nop 0
    s_waitcnt lgkmcnt(2)
    v_exp_f32 v48, v48
    v_mfma_f32_32x32x16_bf16 v[96:111], v[32:35], v[40:43], v[96:111]
    v_exp_f32 v49, v49
    v_exp_f32 v50, v50
    v_exp_f32 v51, v51
    v_exp_f32 v52, v52
    v_mfma_f32_32x32x16_bf16 v[64:79], v[16:19], v[8:11], v[80:95]
    ds_read_b128 v[12:15], v4 offset:2048
    v_exp_f32 v53, v53
    v_exp_f32 v54, v54
    v_exp_f32 v55, v55
    s_mov_b64 exec, s[52:53]
    ds_read_b128 v[28:31], v5 offset:1024
    ds_read_b128 v[32:35], v5 offset:1536
    s_mov_b64 exec, -1
    s_waitcnt lgkmcnt(3)
    v_cvt_pk_bf16_f32 v36, v48, v49
    v_cvt_pk_bf16_f32 v37, v50, v51
    v_cvt_pk_bf16_f32 v38, v52, v53
    v_cvt_pk_bf16_f32 v39, v54, v55
    v_exp_f32 v56, v56
    v_exp_f32 v57, v57
    v_exp_f32 v58, v58
    v_exp_f32 v59, v59
    v_mfma_f32_32x32x16_bf16 v[96:111], v[20:23], v[36:39], v[96:111]
    v_exp_f32 v60, v60
    v_exp_f32 v61, v61
    v_exp_f32 v62, v62
    v_exp_f32 v63, v63
    v_cvt_pk_bf16_f32 v40, v56, v57
    v_cvt_pk_bf16_f32 v41, v58, v59
    v_cvt_pk_bf16_f32 v42, v60, v61
    v_cvt_pk_bf16_f32 v43, v62, v63
    s_waitcnt lgkmcnt(2)
    v_exp_f32 v64, v64
    v_mfma_f32_32x32x16_bf16 v[96:111], v[24:27], v[40:43], v[96:111]
    v_exp_f32 v65, v65
    v_exp_f32 v66, v66
    v_exp_f32 v67, v67
    v_exp_f32 v68, v68
    v_mfma_f32_32x32x16_bf16 v[48:63], v[12:15], v[8:11], v[80:95]
    ds_read_b128 v[16:19], v4 offset:3072
    v_exp_f32 v69, v69
    v_exp_f32 v70, v70
    v_exp_f32 v71, v71
    s_mov_b64 exec, s[52:53]
    ds_read_b128 v[20:23], v5 offset:2048
    ds_read_b128 v[24:27], v5 offset:2560
    s_mov_b64 exec, -1
    s_waitcnt lgkmcnt(3)
    v_cvt_pk_bf16_f32 v36, v64, v65
    v_cvt_pk_bf16_f32 v37, v66, v67
    v_cvt_pk_bf16_f32 v38, v68, v69
    v_cvt_pk_bf16_f32 v39, v70, v71
    v_exp_f32 v72, v72
    v_exp_f32 v73, v73
    v_exp_f32 v74, v74
    v_exp_f32 v75, v75
    v_mfma_f32_32x32x16_bf16 v[96:111], v[28:31], v[36:39], v[96:111]
    v_exp_f32 v76, v76
    v_exp_f32 v77, v77
    v_exp_f32 v78, v78
    v_exp_f32 v79, v79
    v_cvt_pk_bf16_f32 v40, v72, v73
    v_cvt_pk_bf16_f32 v41, v74, v75
    v_cvt_pk_bf16_f32 v42, v76, v77
    v_cvt_pk_bf16_f32 v43, v78, v79
    v_add_u32 v4, 2048, v4
    v_add_u32 v5, 2048, v5
    s_add_u32 s46, s46, 1
    s_cbranch_scc0 K2_LOOP0
    s_waitcnt vmcnt(4)
    s_barrier
    s_mov_b32 s46, 4294967292
.p2align 3
K2_LOOP1:
    s_mov_b32 m0, s48
    s_add_u32 s50, s49, 2097152
    buffer_load_dwordx4 v6, s[20:23], s49 offen lds
    s_add_u32 m0, s48, 65536
    s_add_u32 s48, s48, 8192
    buffer_load_dwordx4 v6, s[20:23], s50 offen lds
    s_add_u32 s49, s49, 8192
    s_nop 0
    s_waitcnt lgkmcnt(2)
    v_exp_f32 v48, v48
    v_mfma_f32_32x32x16_bf16 v[96:111], v[32:35], v[40:43], v[96:111]
    v_exp_f32 v49, v49
    v_exp_f32 v50, v50
    v_exp_f32 v51, v51
    v_exp_f32 v52, v52
    v_mfma_f32_32x32x16_bf16 v[64:79], v[16:19], v[8:11], v[80:95]
    ds_read_b128 v[12:15], v4 offset:2048
    v_exp_f32 v53, v53
    v_exp_f32 v54, v54
    v_exp_f32 v55, v55
    s_mov_b64 exec, s[52:53]
    ds_read_b128 v[28:31], v5 offset:1024
    ds_read_b128 v[32:35], v5 offset:1536
    s_mov_b64 exec, -1
    s_waitcnt lgkmcnt(3)
    v_cvt_pk_bf16_f32 v36, v48, v49
    v_cvt_pk_bf16_f32 v37, v50, v51
    v_cvt_pk_bf16_f32 v38, v52, v53
    v_cvt_pk_bf16_f32 v39, v54, v55
    v_exp_f32 v56, v56
    v_exp_f32 v57, v57
    v_exp_f32 v58, v58
    v_exp_f32 v59, v59
    v_mfma_f32_32x32x16_bf16 v[96:111], v[20:23], v[36:39], v[96:111]
    v_exp_f32 v60, v60
    v_exp_f32 v61, v61
    v_exp_f32 v62, v62
    v_exp_f32 v63, v63
    v_cvt_pk_bf16_f32 v40, v56, v57
    v_cvt_pk_bf16_f32 v41, v58, v59
    v_cvt_pk_bf16_f32 v42, v60, v61
    v_cvt_pk_bf16_f32 v43, v62, v63
    s_waitcnt lgkmcnt(2)
    v_exp_f32 v64, v64
    v_mfma_f32_32x32x16_bf16 v[96:111], v[24:27], v[40:43], v[96:111]
    v_exp_f32 v65, v65
    v_exp_f32 v66, v66
    v_exp_f32 v67, v67
    v_exp_f32 v68, v68
    v_mfma_f32_32x32x16_bf16 v[48:63], v[12:15], v[8:11], v[80:95]
    ds_read_b128 v[16:19], v4 offset:3072
    v_exp_f32 v69, v69
    v_exp_f32 v70, v70
    v_exp_f32 v71, v71
    s_mov_b64 exec, s[52:53]
    ds_read_b128 v[20:23], v5 offset:2048
    ds_read_b128 v[24:27], v5 offset:2560
    s_mov_b64 exec, -1
    s_waitcnt lgkmcnt(3)
    v_cvt_pk_bf16_f32 v36, v64, v65
    v_cvt_pk_bf16_f32 v37, v66, v67
    v_cvt_pk_bf16_f32 v38, v68, v69
    v_cvt_pk_bf16_f32 v39, v70, v71
    v_exp_f32 v72, v72
    v_exp_f32 v73, v73
    v_exp_f32 v74, v74
    v_exp_f32 v75, v75
    v_mfma_f32_32x32x16_bf16 v[96:111], v[28:31], v[36:39], v[96:111]
    v_exp_f32 v76, v76
    v_exp_f32 v77, v77
    v_exp_f32 v78, v78
    v_exp_f32 v79, v79
    v_cvt_pk_bf16_f32 v40, v72, v73
    v_cvt_pk_bf16_f32 v41, v74, v75
    v_cvt_pk_bf16_f32 v42, v76, v77
    v_cvt_pk_bf16_f32 v43, v78, v79
    v_add_u32 v4, 2048, v4
    v_add_u32 v5, 2048, v5
    s_add_u32 s46, s46, 1
    s_cbranch_scc0 K2_LOOP1
    s_waitcnt vmcnt(8)
    s_barrier
    s_mov_b32 s46, 4294967288
.p2align 3
K2_LOOP2:
    s_waitcnt lgkmcnt(2)
    v_exp_f32 v48, v48
    v_mfma_f32_32x32x16_bf16 v[96:111], v[32:35], v[40:43], v[96:111]
    v_exp_f32 v49, v49
    v_exp_f32 v50, v50
    v_exp_f32 v51, v51
    v_exp_f32 v52, v52
    v_mfma_f32_32x32x16_bf16 v[64:79], v[16:19], v[8:11], v[80:95]
    ds_read_b128 v[12:15], v4 offset:2048
    v_exp_f32 v53, v53
    v_exp_f32 v54, v54
    v_exp_f32 v55, v55
    s_mov_b64 exec, s[52:53]
    ds_read_b128 v[28:31], v5 offset:1024
    ds_read_b128 v[32:35], v5 offset:1536
    s_mov_b64 exec, -1
    s_waitcnt lgkmcnt(3)
    v_cvt_pk_bf16_f32 v36, v48, v49
    v_cvt_pk_bf16_f32 v37, v50, v51
    v_cvt_pk_bf16_f32 v38, v52, v53
    v_cvt_pk_bf16_f32 v39, v54, v55
    v_exp_f32 v56, v56
    v_exp_f32 v57, v57
    v_exp_f32 v58, v58
    v_exp_f32 v59, v59
    v_mfma_f32_32x32x16_bf16 v[96:111], v[20:23], v[36:39], v[96:111]
    v_exp_f32 v60, v60
    v_exp_f32 v61, v61
    v_exp_f32 v62, v62
    v_exp_f32 v63, v63
    v_cvt_pk_bf16_f32 v40, v56, v57
    v_cvt_pk_bf16_f32 v41, v58, v59
    v_cvt_pk_bf16_f32 v42, v60, v61
    v_cvt_pk_bf16_f32 v43, v62, v63
    s_waitcnt lgkmcnt(2)
    v_exp_f32 v64, v64
    v_mfma_f32_32x32x16_bf16 v[96:111], v[24:27], v[40:43], v[96:111]
    v_exp_f32 v65, v65
    v_exp_f32 v66, v66
    v_exp_f32 v67, v67
    v_exp_f32 v68, v68
    v_mfma_f32_32x32x16_bf16 v[48:63], v[12:15], v[8:11], v[80:95]
    ds_read_b128 v[16:19], v4 offset:3072
    v_exp_f32 v69, v69
    v_exp_f32 v70, v70
    v_exp_f32 v71, v71
    s_mov_b64 exec, s[52:53]
    ds_read_b128 v[20:23], v5 offset:2048
    ds_read_b128 v[24:27], v5 offset:2560
    s_mov_b64 exec, -1
    s_waitcnt lgkmcnt(3)
    v_cvt_pk_bf16_f32 v36, v64, v65
    v_cvt_pk_bf16_f32 v37, v66, v67
    v_cvt_pk_bf16_f32 v38, v68, v69
    v_cvt_pk_bf16_f32 v39, v70, v71
    v_exp_f32 v72, v72
    v_exp_f32 v73, v73
    v_exp_f32 v74, v74
    v_exp_f32 v75, v75
    v_mfma_f32_32x32x16_bf16 v[96:111], v[28:31], v[36:39], v[96:111]
    v_exp_f32 v76, v76
    v_exp_f32 v77, v77
    v_exp_f32 v78, v78
    v_exp_f32 v79, v79
    v_cvt_pk_bf16_f32 v40, v72, v73
    v_cvt_pk_bf16_f32 v41, v74, v75
    v_cvt_pk_bf16_f32 v42, v76, v77
    v_cvt_pk_bf16_f32 v43, v78, v79
    v_add_u32 v4, 2048, v4
    v_add_u32 v5, 2048, v5
    s_add_u32 s46, s46, 1
    s_cbranch_scc0 K2_LOOP2
    s_waitcnt vmcnt(0)
    s_barrier
    s_lshl_b32 s58, s41, 3
    s_add_u32 s58, s58, s40
    s_lshl_b32 s59, s58, 11
    buffer_load_dwordx4 v[124:127], v6, s[24:27], s59 offen offset:0
    buffer_load_dwordx4 v[124:127], v6, s[24:27], s59 offen offset:1024
    s_mul_i32 s59, s58, 5504
    buffer_load_dwordx4 v[124:127], v6, s[28:31], s59 offen offset:0
    buffer_load_dwordx4 v[124:127], v6, s[28:31], s59 offen offset:1024
    buffer_load_dwordx4 v[124:127], v6, s[28:31], s59 offen offset:2048
    s_add_u32 s59, s59, 3072
    buffer_load_dwordx4 v[124:127], v6, s[28:31], s59 offen offset:0
    buffer_load_dwordx4 v[124:127], v6, s[28:31], s59 offen offset:1024
    buffer_load_dwordx4 v[124:127], v6, s[28:31], s59 offen offset:2048
    s_mov_b32 s46, 4294967279
.p2align 3
K2_LOOP3:
    s_waitcnt lgkmcnt(2)
    v_exp_f32 v48, v48
    v_mfma_f32_32x32x16_bf16 v[96:111], v[32:35], v[40:43], v[96:111]
    v_exp_f32 v49, v49
    v_exp_f32 v50, v50
    v_exp_f32 v51, v51
    v_exp_f32 v52, v52
    v_mfma_f32_32x32x16_bf16 v[64:79], v[16:19], v[8:11], v[80:95]
    ds_read_b128 v[12:15], v4 offset:2048
    v_exp_f32 v53, v53
    v_exp_f32 v54, v54
    v_exp_f32 v55, v55
    s_mov_b64 exec, s[52:53]
    ds_read_b128 v[28:31], v5 offset:1024
    ds_read_b128 v[32:35], v5 offset:1536
    s_mov_b64 exec, -1
    s_waitcnt lgkmcnt(3)
    v_cvt_pk_bf16_f32 v36, v48, v49
    v_cvt_pk_bf16_f32 v37, v50, v51
    v_cvt_pk_bf16_f32 v38, v52, v53
    v_cvt_pk_bf16_f32 v39, v54, v55
    v_exp_f32 v56, v56
    v_exp_f32 v57, v57
    v_exp_f32 v58, v58
    v_exp_f32 v59, v59
    v_mfma_f32_32x32x16_bf16 v[96:111], v[20:23], v[36:39], v[96:111]
    v_exp_f32 v60, v60
    v_exp_f32 v61, v61
    v_exp_f32 v62, v62
    v_exp_f32 v63, v63
    v_cvt_pk_bf16_f32 v40, v56, v57
    v_cvt_pk_bf16_f32 v41, v58, v59
    v_cvt_pk_bf16_f32 v42, v60, v61
    v_cvt_pk_bf16_f32 v43, v62, v63
    s_waitcnt lgkmcnt(2)
    v_exp_f32 v64, v64
    v_mfma_f32_32x32x16_bf16 v[96:111], v[24:27], v[40:43], v[96:111]
    v_exp_f32 v65, v65
    v_exp_f32 v66, v66
    v_exp_f32 v67, v67
    v_exp_f32 v68, v68
    v_mfma_f32_32x32x16_bf16 v[48:63], v[12:15], v[8:11], v[80:95]
    ds_read_b128 v[16:19], v4 offset:3072
    v_exp_f32 v69, v69
    v_exp_f32 v70, v70
    v_exp_f32 v71, v71
    s_mov_b64 exec, s[52:53]
    ds_read_b128 v[20:23], v5 offset:2048
    ds_read_b128 v[24:27], v5 offset:2560
    s_mov_b64 exec, -1
    s_waitcnt lgkmcnt(3)
    v_cvt_pk_bf16_f32 v36, v64, v65
    v_cvt_pk_bf16_f32 v37, v66, v67
    v_cvt_pk_bf16_f32 v38, v68, v69
    v_cvt_pk_bf16_f32 v39, v70, v71
    v_exp_f32 v72, v72
    v_exp_f32 v73, v73
    v_exp_f32 v74, v74
    v_exp_f32 v75, v75
    v_mfma_f32_32x32x16_bf16 v[96:111], v[28:31], v[36:39], v[96:111]
    v_exp_f32 v76, v76
    v_exp_f32 v77, v77
    v_exp_f32 v78, v78
    v_exp_f32 v79, v79
    v_cvt_pk_bf16_f32 v40, v72, v73
    v_cvt_pk_bf16_f32 v41, v74, v75
    v_cvt_pk_bf16_f32 v42, v76, v77
    v_cvt_pk_bf16_f32 v43, v78, v79
    v_add_u32 v4, 2048, v4
    v_add_u32 v5, 2048, v5
    s_add_u32 s46, s46, 1
    s_cbranch_scc0 K2_LOOP3
    s_branch K2_TAIL
K2_PASS1:
    s_mov_b32 s46, 4294967264
.p2align 3
K2_LOOP4:
    s_waitcnt lgkmcnt(2)
    v_exp_f32 v48, v48
    v_mfma_f32_32x32x16_bf16 v[96:111], v[32:35], v[40:43], v[96:111]
    v_exp_f32 v49, v49
    v_exp_f32 v50, v50
    v_exp_f32 v51, v51
    v_exp_f32 v52, v52
    v_mfma_f32_32x32x16_bf16 v[64:79], v[16:19], v[8:11], v[80:95]
    ds_read_b128 v[12:15], v4 offset:2048
    v_exp_f32 v53, v53
    v_exp_f32 v54, v54
    v_exp_f32 v55, v55
    s_mov_b64 exec, s[52:53]
    ds_read_b128 v[28:31], v5 offset:1024
    ds_read_b128 v[32:35], v5 offset:1536
    s_mov_b64 exec, -1
    s_waitcnt lgkmcnt(3)
    v_cvt_pk_bf16_f32 v36, v48, v49
    v_cvt_pk_bf16_f32 v37, v50, v51
    v_cvt_pk_bf16_f32 v38, v52, v53
    v_cvt_pk_bf16_f32 v39, v54, v55
    v_exp_f32 v56, v56
    v_exp_f32 v57, v57
    v_exp_f32 v58, v58
    v_exp_f32 v59, v59
    v_mfma_f32_32x32x16_bf16 v[96:111], v[20:23], v[36:39], v[96:111]
    v_exp_f32 v60, v60
    v_exp_f32 v61, v61
    v_exp_f32 v62, v62
    v_exp_f32 v63, v63
    v_cvt_pk_bf16_f32 v40, v56, v57
    v_cvt_pk_bf16_f32 v41, v58, v59
    v_cvt_pk_bf16_f32 v42, v60, v61
    v_cvt_pk_bf16_f32 v43, v62, v63
    s_waitcnt lgkmcnt(2)
    v_exp_f32 v64, v64
    v_mfma_f32_32x32x16_bf16 v[96:111], v[24:27], v[40:43], v[96:111]
    v_exp_f32 v65, v65
    v_exp_f32 v66, v66
    v_exp_f32 v67, v67
    v_exp_f32 v68, v68
    v_mfma_f32_32x32x16_bf16 v[48:63], v[12:15], v[8:11], v[80:95]
    ds_read_b128 v[16:19], v4 offset:3072
    v_exp_f32 v69, v69
    v_exp_f32 v70, v70
    v_exp_f32 v71, v71
    s_mov_b64 exec, s[52:53]
    ds_read_b128 v[20:23], v5 offset:2048
    ds_read_b128 v[24:27], v5 offset:2560
    s_mov_b64 exec, -1
    s_waitcnt lgkmcnt(3)
    v_cvt_pk_bf16_f32 v36, v64, v65
    v_cvt_pk_bf16_f32 v37, v66, v67
    v_cvt_pk_bf16_f32 v38, v68, v69
    v_cvt_pk_bf16_f32 v39, v70, v71
    v_exp_f32 v72, v72
    v_exp_f32 v73, v73
    v_exp_f32 v74, v74
    v_exp_f32 v75, v75
    v_mfma_f32_32x32x16_bf16 v[96:111], v[28:31], v[36:39], v[96:111]
    v_exp_f32 v76, v76
    v_exp_f32 v77, v77
    v_exp_f32 v78, v78
    v_exp_f32 v79, v79
    v_cvt_pk_bf16_f32 v40, v72, v73
    v_cvt_pk_bf16_f32 v41, v74, v75
    v_cvt_pk_bf16_f32 v42, v76, v77
    v_cvt_pk_bf16_f32 v43, v78, v79
    v_add_u32 v4, 2048, v4
    v_add_u32 v5, 2048, v5
    s_add_u32 s46, s46, 1
    s_cbranch_scc0 K2_LOOP4
K2_TAIL:
    s_nop 1
    v_mfma_f32_32x32x16_bf16 v[96:111], v[32:35], v[40:43], v[96:111]
    s_waitcnt lgkmcnt(0)
    s_nop 15
    v_mov_b32 v113, v104
    v_mov_b32 v114, v104
    s_nop 1
    v_permlane32_swap_b32 v113, v114
    s_cmp_lg_u32 s45, 0
    s_cbranch_scc1 K2_FIN
    v_max3_f32 v115, |v96|, |v97|, |v98|
    v_max3_f32 v115, v115, |v99|, |v100|
    v_max3_f32 v115, v115, |v101|, |v102|
    v_max_f32 v115, v115, |v103|
    s_mov_b32 s54, 0x5d800000
    s_mov_b32 s55, 0x7f000000
    v_cmp_nlt_f32 vcc, v113, s54
    v_cmp_nlt_f32 s[56:57], v115, s55
    s_nop 1
    s_or_b64 vcc, vcc, s[56:57]
    s_cbranch_vccz K2_FIN
    v_lshlrev_b32 v4, 4, v1
    v_mov_b32 v112, 0xff800000
    s_mov_b32 s46, 0
K2_MAXLOOP:
    ds_read_b128 v[12:15], v4
    s_waitcnt lgkmcnt(0)
    v_mfma_f32_32x32x16_bf16 v[48:63], v[12:15], v[8:11], 0
    s_nop 15
    v_max3_f32 v112, v112, v48, v49
    v_max3_f32 v112, v112, v50, v51
    v_max3_f32 v112, v112, v52, v53
    v_max3_f32 v112, v112, v54, v55
    v_max3_f32 v112, v112, v56, v57
    v_max3_f32 v112, v112, v58, v59
    v_max3_f32 v112, v112, v60, v61
    v_max3_f32 v112, v112, v62, v63
    v_add_u32 v4, 1024, v4
    s_add_u32 s46, s46, 1
    s_cmp_lt_u32 s46, 64
    s_cbranch_scc1 K2_MAXLOOP
    v_mov_b32 v113, v112
    v_mov_b32 v114, v112
    s_nop 1
    v_permlane32_swap_b32 v113, v114
    s_nop 1
    v_max_f32 v112, v113, v114
    s_mov_b32 s45, 1
    s_branch K2_RUN
K2_FIN:
    v_rcp_f32 v113, v113
    s_nop 0
    v_mul_f32 v96, v96, v113
    v_mul_f32 v97, v97, v113
    v_mul_f32 v98, v98, v113
    v_mul_f32 v99, v99, v113
    v_mul_f32 v100, v100, v113
    v_mul_f32 v101, v101, v113
    v_mul_f32 v102, v102, v113
    v_mul_f32 v103, v103, v113
    v_cvt_pk_bf16_f32 v36, v96, v97
    v_cvt_pk_bf16_f32 v37, v98, v99
    v_cvt_pk_bf16_f32 v38, v100, v101
    v_cvt_pk_bf16_f32 v39, v102, v103
    v_and_b32 v2, 31, v1
    v_lshrrev_b32 v3, 5, v1
    v_lshlrev_b32 v2, 10, v2
    v_lshl_add_u32 v2, v3, 4, v2
    s_lshl_b32 s43, s42, 8
    s_lshl_b32 s44, s40, 5
    s_add_u32 s43, s43, s44
    s_lshl_b32 s43, s43, 10
    s_lshl_b32 s44, s41, 5
    s_add_u32 s43, s43, s44
    s_add_u32 s43, s43, 6291456
    buffer_store_dwordx4 v[36:39], v2, s[20:23], s43 offen
K2_END:
    s_endpgm
K2_G:
    s_load_dwordx2 s[4:5], s[0:1], 0
    s_load_dwordx4 s[8:11], s[0:1], 32
    s_sub_u32 s48, s40, 8
    s_lshl_b32 s43, s41, 2
    s_add_u32 s43, s43, s48
    s_and_b32 s44, s43, 7
    s_lshl_b32 s46, s42, 3
    s_add_u32 s46, s46, s44
    s_lshl_b32 s46, s46, 5
    s_lshr_b32 s44, s43, 3
    s_mul_i32 s45, s44, 96
    s_cmp_lt_u32 s44, 15
    s_cbranch_scc1 K2_GGO
    s_barrier
    s_barrier
    s_barrier
    s_barrier
    s_endpgm
K2_GGO:
    s_mul_i32 s47, s48, 6144
    s_add_u32 s47, s47, 131072
    v_add_u32 v2, 0, v1
    v_mul_u32_u24 v3, 5462, v2
    v_lshrrev_b32 v3, 16, v3
    v_mul_u32_u24 v12, 12, v3
    v_sub_u32 v12, v2, v12
    v_mul_u32_u24 v3, 2752, v3
    v_lshl_add_u32 v3, v12, 4, v3
    s_lshl_b32 s43, s45, 1
    v_add_u32 v4, s43, v3
    v_add_u32 v2, 64, v1
    v_mul_u32_u24 v3, 5462, v2
    v_lshrrev_b32 v3, 16, v3
    v_mul_u32_u24 v12, 12, v3
    v_sub_u32 v12, v2, v12
    v_mul_u32_u24 v3, 2752, v3
    v_lshl_add_u32 v3, v12, 4, v3
    s_lshl_b32 s43, s45, 1
    v_add_u32 v5, s43, v3
    v_add_u32 v2, 128, v1
    v_mul_u32_u24 v3, 5462, v2
    v_lshrrev_b32 v3, 16, v3
    v_mul_u32_u24 v12, 12, v3
    v_sub_u32 v12, v2, v12
    v_mul_u32_u24 v3, 2752, v3
    v_lshl_add_u32 v3, v12, 4, v3
    s_lshl_b32 s43, s45, 1
    v_add_u32 v6, s43, v3
    v_and_b32 v2, 31, v1
    v_add_u32 v2, s46, v2
    v_lshlrev_b32 v2, 10, v2
    v_lshrrev_b32 v3, 5, v1
    v_lshl_add_u32 v7, v3, 4, v2
    v_lshrrev_b32 v2, 5, v1
    v_lshlrev_b32 v2, 3, v2
    v_bfe_u32 v3, v1, 2, 2
    v_add_u32 v2, v2, v3
    v_mul_u32_u24 v2, 192, v2
    v_and_b32 v3, 3, v1
    v_lshl_add_u32 v2, v3, 3, v2
    v_bfe_u32 v3, v1, 4, 1
    v_lshl_add_u32 v2, v3, 5, v2
    v_add_u32 v8, s47, v2
    s_waitcnt lgkmcnt(0)
    s_mov_b32 s24, s4
    s_and_b32 s25, s5, 0xffff
    s_mov_b32 s26, 2097152
    s_mov_b32 s27, 0x00020000
    s_mov_b32 s28, s8
    s_and_b32 s29, s9, 0xffff
    s_mov_b32 s30, 1409024
    s_mov_b32 s31, 0x00020000
    s_mov_b32 s32, s10
    s_and_b32 s33, s11, 0xffff
    s_mov_b32 s34, 2752
    s_mov_b32 s35, 0x00020000
    v_lshlrev_b32 v2, 1, v1
    v_cmp_gt_u32 vcc, 32, v1
    v_mov_b32 v3, 0x7fff0000
    s_lshl_b32 s43, s45, 1
    v_cndmask_b32 v2, v3, v2, vcc
    buffer_load_ushort v9, v2, s[32:35], s43 offen offset:0
    buffer_load_ushort v10, v2, s[32:35], s43 offen offset:64
    buffer_load_ushort v11, v2, s[32:35], s43 offen offset:128
    buffer_load_dwordx4 v[16:19], v7, s[24:27], 0 offen offset:0
    s_mov_b32 s43, 0
    s_add_u32 m0, s47, 0
    s_nop 0
    buffer_load_dwordx4 v4, s[28:31], s43 offen lds
    s_add_u32 m0, s47, 1024
    s_nop 0
    buffer_load_dwordx4 v5, s[28:31], s43 offen lds
    s_add_u32 m0, s47, 2048
    s_nop 0
    buffer_load_dwordx4 v6, s[28:31], s43 offen lds
    buffer_load_dwordx4 v[20:23], v7, s[24:27], 0 offen offset:32
    s_mov_b32 s43, 44032
    s_add_u32 m0, s47, 3072
    s_nop 0
    buffer_load_dwordx4 v4, s[28:31], s43 offen lds
    s_add_u32 m0, s47, 4096
    s_nop 0
    buffer_load_dwordx4 v5, s[28:31], s43 offen lds
    s_add_u32 m0, s47, 5120
    s_nop 0
    buffer_load_dwordx4 v6, s[28:31], s43 offen lds
    buffer_load_dwordx4 v[24:27], v7, s[24:27], 0 offen offset:64
    buffer_load_dwordx4 v[28:31], v7, s[24:27], 0 offen offset:96
    v_mov_b32 v64, 0
    v_mov_b32 v65, 0
    v_mov_b32 v66, 0
    v_mov_b32 v67, 0
    v_mov_b32 v68, 0
    v_mov_b32 v69, 0
    v_mov_b32 v70, 0
    v_mov_b32 v71, 0
    v_mov_b32 v72, 0
    v_mov_b32 v73, 0
    v_mov_b32 v74, 0
    v_mov_b32 v75, 0
    v_mov_b32 v76, 0
    v_mov_b32 v77, 0
    v_mov_b32 v78, 0
    v_mov_b32 v79, 0
    v_mov_b32 v80, 0
    v_mov_b32 v81, 0
    v_mov_b32 v82, 0
    v_mov_b32 v83, 0
    v_mov_b32 v84, 0
    v_mov_b32 v85, 0
    v_mov_b32 v86, 0
    v_mov_b32 v87, 0
    v_mov_b32 v88, 0
    v_mov_b32 v89, 0
    v_mov_b32 v90, 0
    v_mov_b32 v91, 0
    v_mov_b32 v92, 0
    v_mov_b32 v93, 0
    v_mov_b32 v94, 0
    v_mov_b32 v95, 0
    v_mov_b32 v96, 0
    v_mov_b32 v97, 0
    v_mov_b32 v98, 0
    v_mov_b32 v99, 0
    v_mov_b32 v100, 0
    v_mov_b32 v101, 0
    v_mov_b32 v102, 0
    v_mov_b32 v103, 0
    v_mov_b32 v104, 0
    v_mov_b32 v105, 0
    v_mov_b32 v106, 0
    v_mov_b32 v107, 0
    v_mov_b32 v108, 0
    v_mov_b32 v109, 0
    v_mov_b32 v110, 0
    v_mov_b32 v111, 0
    s_barrier
    s_waitcnt vmcnt(6)
    ds_read_b64_tr_b16 v[32:33], v8 offset:0
    ds_read_b64_tr_b16 v[34:35], v8 offset:768
    ds_read_b64_tr_b16 v[36:37], v8 offset:64
    ds_read_b64_tr_b16 v[38:39], v8 offset:832
    ds_read_b64_tr_b16 v[40:41], v8 offset:128
    ds_read_b64_tr_b16 v[42:43], v8 offset:896
    s_waitcnt lgkmcnt(0)
    v_mfma_f32_32x32x16_bf16 v[64:79], v[32:35], v[16:19], v[64:79]
    v_mfma_f32_32x32x16_bf16 v[80:95], v[36:39], v[16:19], v[80:95]
    v_mfma_f32_32x32x16_bf16 v[96:111], v[40:43], v[16:19], v[96:111]
    s_mov_b32 s43, 88064
    s_add_u32 m0, s47, 0
    s_nop 0
    buffer_load_dwordx4 v4, s[28:31], s43 offen lds
    s_add_u32 m0, s47, 1024
    s_nop 0
    buffer_load_dwordx4 v5, s[28:31], s43 offen lds
    s_add_u32 m0, s47, 2048
    s_nop 0
    buffer_load_dwordx4 v6, s[28:31], s43 offen lds
    buffer_load_dwordx4 v[16:19], v7, s[24:27], 0 offen offset:128
    s_waitcnt vmcnt(6)
    ds_read_b64_tr_b16 v[32:33], v8 offset:3072
    ds_read_b64_tr_b16 v[34:35], v8 offset:3840
    ds_read_b64_tr_b16 v[36:37], v8 offset:3136
    ds_read_b64_tr_b16 v[38:39], v8 offset:3904
    ds_read_b64_tr_b16 v[40:41], v8 offset:3200
    ds_read_b64_tr_b16 v[42:43], v8 offset:3968
    s_waitcnt lgkmcnt(0)
    v_mfma_f32_32x32x16_bf16 v[64:79], v[32:35], v[20:23], v[64:79]
    v_mfma_f32_32x32x16_bf16 v[80:95], v[36:39], v[20:23], v[80:95]
    v_mfma_f32_32x32x16_bf16 v[96:111], v[40:43], v[20:23], v[96:111]
    s_mov_b32 s43, 132096
    s_add_u32 m0, s47, 3072
    s_nop 0
    buffer_load_dwordx4 v4, s[28:31], s43 offen lds
    s_add_u32 m0, s47, 4096
    s_nop 0
    buffer_load_dwordx4 v5, s[28:31], s43 offen lds
    s_add_u32 m0, s47, 5120
    s_nop 0
    buffer_load_dwordx4 v6, s[28:31], s43 offen lds
    buffer_load_dwordx4 v[20:23], v7, s[24:27], 0 offen offset:160
    s_barrier
    s_waitcnt vmcnt(5)
    ds_read_b64_tr_b16 v[32:33], v8 offset:0
    ds_read_b64_tr_b16 v[34:35], v8 offset:768
    ds_read_b64_tr_b16 v[36:37], v8 offset:64
    ds_read_b64_tr_b16 v[38:39], v8 offset:832
    ds_read_b64_tr_b16 v[40:41], v8 offset:128
    ds_read_b64_tr_b16 v[42:43], v8 offset:896
    s_waitcnt lgkmcnt(0)
    v_mfma_f32_32x32x16_bf16 v[64:79], v[32:35], v[24:27], v[64:79]
    v_mfma_f32_32x32x16_bf16 v[80:95], v[36:39], v[24:27], v[80:95]
    v_mfma_f32_32x32x16_bf16 v[96:111], v[40:43], v[24:27], v[96:111]
    s_mov_b32 s43, 176128
    s_add_u32 m0, s47, 0
    s_nop 0
    buffer_load_dwordx4 v4, s[28:31], s43 offen lds
    s_add_u32 m0, s47, 1024
    s_nop 0
    buffer_load_dwordx4 v5, s[28:31], s43 offen lds
    s_add_u32 m0, s47, 2048
    s_nop 0
    buffer_load_dwordx4 v6, s[28:31], s43 offen lds
    buffer_load_dwordx4 v[24:27], v7, s[24:27], 0 offen offset:192
    s_waitcnt vmcnt(5)
    ds_read_b64_tr_b16 v[32:33], v8 offset:3072
    ds_read_b64_tr_b16 v[34:35], v8 offset:3840
    ds_read_b64_tr_b16 v[36:37], v8 offset:3136
    ds_read_b64_tr_b16 v[38:39], v8 offset:3904
    ds_read_b64_tr_b16 v[40:41], v8 offset:3200
    ds_read_b64_tr_b16 v[42:43], v8 offset:3968
    s_waitcnt lgkmcnt(0)
    v_mfma_f32_32x32x16_bf16 v[64:79], v[32:35], v[28:31], v[64:79]
    v_mfma_f32_32x32x16_bf16 v[80:95], v[36:39], v[28:31], v[80:95]
    v_mfma_f32_32x32x16_bf16 v[96:111], v[40:43], v[28:31], v[96:111]
    s_mov_b32 s43, 220160
    s_add_u32 m0, s47, 3072
    s_nop 0
    buffer_load_dwordx4 v4, s[28:31], s43 offen lds
    s_add_u32 m0, s47, 4096
    s_nop 0
    buffer_load_dwordx4 v5, s[28:31], s43 offen lds
    s_add_u32 m0, s47, 5120
    s_nop 0
    buffer_load_dwordx4 v6, s[28:31], s43 offen lds
    buffer_load_dwordx4 v[28:31], v7, s[24:27], 0 offen offset:224
    s_waitcnt vmcnt(5)
    ds_read_b64_tr_b16 v[32:33], v8 offset:0
    ds_read_b64_tr_b16 v[34:35], v8 offset:768
    ds_read_b64_tr_b16 v[36:37], v8 offset:64
    ds_read_b64_tr_b16 v[38:39], v8 offset:832
    ds_read_b64_tr_b16 v[40:41], v8 offset:128
    ds_read_b64_tr_b16 v[42:43], v8 offset:896
    s_waitcnt lgkmcnt(0)
    v_mfma_f32_32x32x16_bf16 v[64:79], v[32:35], v[16:19], v[64:79]
    v_mfma_f32_32x32x16_bf16 v[80:95], v[36:39], v[16:19], v[80:95]
    v_mfma_f32_32x32x16_bf16 v[96:111], v[40:43], v[16:19], v[96:111]
    s_mov_b32 s43, 264192
    s_add_u32 m0, s47, 0
    s_nop 0
    buffer_load_dwordx4 v4, s[28:31], s43 offen lds
    s_add_u32 m0, s47, 1024
    s_nop 0
    buffer_load_dwordx4 v5, s[28:31], s43 offen lds
    s_add_u32 m0, s47, 2048
    s_nop 0
    buffer_load_dwordx4 v6, s[28:31], s43 offen lds
    buffer_load_dwordx4 v[16:19], v7, s[24:27], 0 offen offset:256
    s_waitcnt vmcnt(5)
    ds_read_b64_tr_b16 v[32:33], v8 offset:3072
    ds_read_b64_tr_b16 v[34:35], v8 offset:3840
    ds_read_b64_tr_b16 v[36:37], v8 offset:3136
    ds_read_b64_tr_b16 v[38:39], v8 offset:3904
    ds_read_b64_tr_b16 v[40:41], v8 offset:3200
    ds_read_b64_tr_b16 v[42:43], v8 offset:3968
    s_waitcnt lgkmcnt(0)
    v_mfma_f32_32x32x16_bf16 v[64:79], v[32:35], v[20:23], v[64:79]
    v_mfma_f32_32x32x16_bf16 v[80:95], v[36:39], v[20:23], v[80:95]
    v_mfma_f32_32x32x16_bf16 v[96:111], v[40:43], v[20:23], v[96:111]
    s_mov_b32 s43, 308224
    s_add_u32 m0, s47, 3072
    s_nop 0
    buffer_load_dwordx4 v4, s[28:31], s43 offen lds
    s_add_u32 m0, s47, 4096
    s_nop 0
    buffer_load_dwordx4 v5, s[28:31], s43 offen lds
    s_add_u32 m0, s47, 5120
    s_nop 0
    buffer_load_dwordx4 v6, s[28:31], s43 offen lds
    buffer_load_dwordx4 v[20:23], v7, s[24:27], 0 offen offset:288
    s_barrier
    s_waitcnt vmcnt(5)
    ds_read_b64_tr_b16 v[32:33], v8 offset:0
    ds_read_b64_tr_b16 v[34:35], v8 offset:768
    ds_read_b64_tr_b16 v[36:37], v8 offset:64
    ds_read_b64_tr_b16 v[38:39], v8 offset:832
    ds_read_b64_tr_b16 v[40:41], v8 offset:128
    ds_read_b64_tr_b16 v[42:43], v8 offset:896
    s_waitcnt lgkmcnt(0)
    v_mfma_f32_32x32x16_bf16 v[64:79], v[32:35], v[24:27], v[64:79]
    v_mfma_f32_32x32x16_bf16 v[80:95], v[36:39], v[24:27], v[80:95]
    v_mfma_f32_32x32x16_bf16 v[96:111], v[40:43], v[24:27], v[96:111]
    s_mov_b32 s43, 352256
    s_add_u32 m0, s47, 0
    s_nop 0
    buffer_load_dwordx4 v4, s[28:31], s43 offen lds
    s_add_u32 m0, s47, 1024
    s_nop 0
    buffer_load_dwordx4 v5, s[28:31], s43 offen lds
    s_add_u32 m0, s47, 2048
    s_nop 0
    buffer_load_dwordx4 v6, s[28:31], s43 offen lds
    buffer_load_dwordx4 v[24:27], v7, s[24:27], 0 offen offset:320
    s_waitcnt vmcnt(5)
    ds_read_b64_tr_b16 v[32:33], v8 offset:3072
    ds_read_b64_tr_b16 v[34:35], v8 offset:3840
    ds_read_b64_tr_b16 v[36:37], v8 offset:3136
    ds_read_b64_tr_b16 v[38:39], v8 offset:3904
    ds_read_b64_tr_b16 v[40:41], v8 offset:3200
    ds_read_b64_tr_b16 v[42:43], v8 offset:3968
    s_waitcnt lgkmcnt(0)
    v_mfma_f32_32x32x16_bf16 v[64:79], v[32:35], v[28:31], v[64:79]
    v_mfma_f32_32x32x16_bf16 v[80:95], v[36:39], v[28:31], v[80:95]
    v_mfma_f32_32x32x16_bf16 v[96:111], v[40:43], v[28:31], v[96:111]
    s_mov_b32 s43, 396288
    s_add_u32 m0, s47, 3072
    s_nop 0
    buffer_load_dwordx4 v4, s[28:31], s43 offen lds
    s_add_u32 m0, s47, 4096
    s_nop 0
    buffer_load_dwordx4 v5, s[28:31], s43 offen lds
    s_add_u32 m0, s47, 5120
    s_nop 0
    buffer_load_dwordx4 v6, s[28:31], s43 offen lds
    buffer_load_dwordx4 v[28:31], v7, s[24:27], 0 offen offset:352
    s_waitcnt vmcnt(5)
    ds_read_b64_tr_b16 v[32:33], v8 offset:0
    ds_read_b64_tr_b16 v[34:35], v8 offset:768
    ds_read_b64_tr_b16 v[36:37], v8 offset:64
    ds_read_b64_tr_b16 v[38:39], v8 offset:832
    ds_read_b64_tr_b16 v[40:41], v8 offset:128
    ds_read_b64_tr_b16 v[42:43], v8 offset:896
    s_waitcnt lgkmcnt(0)
    v_mfma_f32_32x32x16_bf16 v[64:79], v[32:35], v[16:19], v[64:79]
    v_mfma_f32_32x32x16_bf16 v[80:95], v[36:39], v[16:19], v[80:95]
    v_mfma_f32_32x32x16_bf16 v[96:111], v[40:43], v[16:19], v[96:111]
    s_mov_b32 s43, 440320
    s_add_u32 m0, s47, 0
    s_nop 0
    buffer_load_dwordx4 v4, s[28:31], s43 offen lds
    s_add_u32 m0, s47, 1024
    s_nop 0
    buffer_load_dwordx4 v5, s[28:31], s43 offen lds
    s_add_u32 m0, s47, 2048
    s_nop 0
    buffer_load_dwordx4 v6, s[28:31], s43 offen lds
    buffer_load_dwordx4 v[16:19], v7, s[24:27], 0 offen offset:384
    s_waitcnt vmcnt(5)
    ds_read_b64_tr_b16 v[32:33], v8 offset:3072
    ds_read_b64_tr_b16 v[34:35], v8 offset:3840
    ds_read_b64_tr_b16 v[36:37], v8 offset:3136
    ds_read_b64_tr_b16 v[38:39], v8 offset:3904
    ds_read_b64_tr_b16 v[40:41], v8 offset:3200
    ds_read_b64_tr_b16 v[42:43], v8 offset:3968
    s_waitcnt lgkmcnt(0)
    v_mfma_f32_32x32x16_bf16 v[64:79], v[32:35], v[20:23], v[64:79]
    v_mfma_f32_32x32x16_bf16 v[80:95], v[36:39], v[20:23], v[80:95]
    v_mfma_f32_32x32x16_bf16 v[96:111], v[40:43], v[20:23], v[96:111]
    s_mov_b32 s43, 484352
    s_add_u32 m0, s47, 3072
    s_nop 0
    buffer_load_dwordx4 v4, s[28:31], s43 offen lds
    s_add_u32 m0, s47, 4096
    s_nop 0
    buffer_load_dwordx4 v5, s[28:31], s43 offen lds
    s_add_u32 m0, s47, 5120
    s_nop 0
    buffer_load_dwordx4 v6, s[28:31], s43 offen lds
    buffer_load_dwordx4 v[20:23], v7, s[24:27], 0 offen offset:416
    s_waitcnt vmcnt(5)
    ds_read_b64_tr_b16 v[32:33], v8 offset:0
    ds_read_b64_tr_b16 v[34:35], v8 offset:768
    ds_read_b64_tr_b16 v[36:37], v8 offset:64
    ds_read_b64_tr_b16 v[38:39], v8 offset:832
    ds_read_b64_tr_b16 v[40:41], v8 offset:128
    ds_read_b64_tr_b16 v[42:43], v8 offset:896
    s_waitcnt lgkmcnt(0)
    v_mfma_f32_32x32x16_bf16 v[64:79], v[32:35], v[24:27], v[64:79]
    v_mfma_f32_32x32x16_bf16 v[80:95], v[36:39], v[24:27], v[80:95]
    v_mfma_f32_32x32x16_bf16 v[96:111], v[40:43], v[24:27], v[96:111]
    s_mov_b32 s43, 528384
    s_add_u32 m0, s47, 0
    s_nop 0
    buffer_load_dwordx4 v4, s[28:31], s43 offen lds
    s_add_u32 m0, s47, 1024
    s_nop 0
    buffer_load_dwordx4 v5, s[28:31], s43 offen lds
    s_add_u32 m0, s47, 2048
    s_nop 0
    buffer_load_dwordx4 v6, s[28:31], s43 offen lds
    buffer_load_dwordx4 v[24:27], v7, s[24:27], 0 offen offset:448
    s_waitcnt vmcnt(5)
    ds_read_b64_tr_b16 v[32:33], v8 offset:3072
    ds_read_b64_tr_b16 v[34:35], v8 offset:3840
    ds_read_b64_tr_b16 v[36:37], v8 offset:3136
    ds_read_b64_tr_b16 v[38:39], v8 offset:3904
    ds_read_b64_tr_b16 v[40:41], v8 offset:3200
    ds_read_b64_tr_b16 v[42:43], v8 offset:3968
    s_waitcnt lgkmcnt(0)
    v_mfma_f32_32x32x16_bf16 v[64:79], v[32:35], v[28:31], v[64:79]
    v_mfma_f32_32x32x16_bf16 v[80:95], v[36:39], v[28:31], v[80:95]
    v_mfma_f32_32x32x16_bf16 v[96:111], v[40:43], v[28:31], v[96:111]
    s_mov_b32 s43, 572416
    s_add_u32 m0, s47, 3072
    s_nop 0
    buffer_load_dwordx4 v4, s[28:31], s43 offen lds
    s_add_u32 m0, s47, 4096
    s_nop 0
    buffer_load_dwordx4 v5, s[28:31], s43 offen lds
    s_add_u32 m0, s47, 5120
    s_nop 0
    buffer_load_dwordx4 v6, s[28:31], s43 offen lds
    buffer_load_dwordx4 v[28:31], v7, s[24:27], 0 offen offset:480
    s_barrier
    s_waitcnt vmcnt(5)
    ds_read_b64_tr_b16 v[32:33], v8 offset:0
    ds_read_b64_tr_b16 v[34:35], v8 offset:768
    ds_read_b64_tr_b16 v[36:37], v8 offset:64
    ds_read_b64_tr_b16 v[38:39], v8 offset:832
    ds_read_b64_tr_b16 v[40:41], v8 offset:128
    ds_read_b64_tr_b16 v[42:43], v8 offset:896
    s_waitcnt lgkmcnt(0)
    v_mfma_f32_32x32x16_bf16 v[64:79], v[32:35], v[16:19], v[64:79]
    v_mfma_f32_32x32x16_bf16 v[80:95], v[36:39], v[16:19], v[80:95]
    v_mfma_f32_32x32x16_bf16 v[96:111], v[40:43], v[16:19], v[96:111]
    s_mov_b32 s43, 616448
    s_add_u32 m0, s47, 0
    s_nop 0
    buffer_load_dwordx4 v4, s[28:31], s43 offen lds
    s_add_u32 m0, s47, 1024
    s_nop 0
    buffer_load_dwordx4 v5, s[28:31], s43 offen lds
    s_add_u32 m0, s47, 2048
    s_nop 0
    buffer_load_dwordx4 v6, s[28:31], s43 offen lds
    buffer_load_dwordx4 v[16:19], v7, s[24:27], 0 offen offset:512
    s_waitcnt vmcnt(5)
    ds_read_b64_tr_b16 v[32:33], v8 offset:3072
    ds_read_b64_tr_b16 v[34:35], v8 offset:3840
    ds_read_b64_tr_b16 v[36:37], v8 offset:3136
    ds_read_b64_tr_b16 v[38:39], v8 offset:3904
    ds_read_b64_tr_b16 v[40:41], v8 offset:3200
    ds_read_b64_tr_b16 v[42:43], v8 offset:3968
    s_waitcnt lgkmcnt(0)
    v_mfma_f32_32x32x16_bf16 v[64:79], v[32:35], v[20:23], v[64:79]
    v_mfma_f32_32x32x16_bf16 v[80:95], v[36:39], v[20:23], v[80:95]
    v_mfma_f32_32x32x16_bf16 v[96:111], v[40:43], v[20:23], v[96:111]
    s_mov_b32 s43, 660480
    s_add_u32 m0, s47, 3072
    s_nop 0
    buffer_load_dwordx4 v4, s[28:31], s43 offen lds
    s_add_u32 m0, s47, 4096
    s_nop 0
    buffer_load_dwordx4 v5, s[28:31], s43 offen lds
    s_add_u32 m0, s47, 5120
    s_nop 0
    buffer_load_dwordx4 v6, s[28:31], s43 offen lds
    buffer_load_dwordx4 v[20:23], v7, s[24:27], 0 offen offset:544
    s_waitcnt vmcnt(5)
    ds_read_b64_tr_b16 v[32:33], v8 offset:0
    ds_read_b64_tr_b16 v[34:35], v8 offset:768
    ds_read_b64_tr_b16 v[36:37], v8 offset:64
    ds_read_b64_tr_b16 v[38:39], v8 offset:832
    ds_read_b64_tr_b16 v[40:41], v8 offset:128
    ds_read_b64_tr_b16 v[42:43], v8 offset:896
    s_waitcnt lgkmcnt(0)
    v_mfma_f32_32x32x16_bf16 v[64:79], v[32:35], v[24:27], v[64:79]
    v_mfma_f32_32x32x16_bf16 v[80:95], v[36:39], v[24:27], v[80:95]
    v_mfma_f32_32x32x16_bf16 v[96:111], v[40:43], v[24:27], v[96:111]
    s_mov_b32 s43, 704512
    s_add_u32 m0, s47, 0
    s_nop 0
    buffer_load_dwordx4 v4, s[28:31], s43 offen lds
    s_add_u32 m0, s47, 1024
    s_nop 0
    buffer_load_dwordx4 v5, s[28:31], s43 offen lds
    s_add_u32 m0, s47, 2048
    s_nop 0
    buffer_load_dwordx4 v6, s[28:31], s43 offen lds
    buffer_load_dwordx4 v[24:27], v7, s[24:27], 0 offen offset:576
    s_waitcnt vmcnt(5)
    ds_read_b64_tr_b16 v[32:33], v8 offset:3072
    ds_read_b64_tr_b16 v[34:35], v8 offset:3840
    ds_read_b64_tr_b16 v[36:37], v8 offset:3136
    ds_read_b64_tr_b16 v[38:39], v8 offset:3904
    ds_read_b64_tr_b16 v[40:41], v8 offset:3200
    ds_read_b64_tr_b16 v[42:43], v8 offset:3968
    s_waitcnt lgkmcnt(0)
    v_mfma_f32_32x32x16_bf16 v[64:79], v[32:35], v[28:31], v[64:79]
    v_mfma_f32_32x32x16_bf16 v[80:95], v[36:39], v[28:31], v[80:95]
    v_mfma_f32_32x32x16_bf16 v[96:111], v[40:43], v[28:31], v[96:111]
    s_mov_b32 s43, 748544
    s_add_u32 m0, s47, 3072
    s_nop 0
    buffer_load_dwordx4 v4, s[28:31], s43 offen lds
    s_add_u32 m0, s47, 4096
    s_nop 0
    buffer_load_dwordx4 v5, s[28:31], s43 offen lds
    s_add_u32 m0, s47, 5120
    s_nop 0
    buffer_load_dwordx4 v6, s[28:31], s43 offen lds
    buffer_load_dwordx4 v[28:31], v7, s[24:27], 0 offen offset:608
    s_waitcnt vmcnt(5)
    ds_read_b64_tr_b16 v[32:33], v8 offset:0
    ds_read_b64_tr_b16 v[34:35], v8 offset:768
    ds_read_b64_tr_b16 v[36:37], v8 offset:64
    ds_read_b64_tr_b16 v[38:39], v8 offset:832
    ds_read_b64_tr_b16 v[40:41], v8 offset:128
    ds_read_b64_tr_b16 v[42:43], v8 offset:896
    s_waitcnt lgkmcnt(0)
    v_mfma_f32_32x32x16_bf16 v[64:79], v[32:35], v[16:19], v[64:79]
    v_mfma_f32_32x32x16_bf16 v[80:95], v[36:39], v[16:19], v[80:95]
    v_mfma_f32_32x32x16_bf16 v[96:111], v[40:43], v[16:19], v[96:111]
    s_mov_b32 s43, 792576
    s_add_u32 m0, s47, 0
    s_nop 0
    buffer_load_dwordx4 v4, s[28:31], s43 offen lds
    s_add_u32 m0, s47, 1024
    s_nop 0
    buffer_load_dwordx4 v5, s[28:31], s43 offen lds
    s_add_u32 m0, s47, 2048
    s_nop 0
    buffer_load_dwordx4 v6, s[28:31], s43 offen lds
    buffer_load_dwordx4 v[16:19], v7, s[24:27], 0 offen offset:640
    s_waitcnt vmcnt(5)
    ds_read_b64_tr_b16 v[32:33], v8 offset:3072
    ds_read_b64_tr_b16 v[34:35], v8 offset:3840
    ds_read_b64_tr_b16 v[36:37], v8 offset:3136
    ds_read_b64_tr_b16 v[38:39], v8 offset:3904
    ds_read_b64_tr_b16 v[40:41], v8 offset:3200
    ds_read_b64_tr_b16 v[42:43], v8 offset:3968
    s_waitcnt lgkmcnt(0)
    v_mfma_f32_32x32x16_bf16 v[64:79], v[32:35], v[20:23], v[64:79]
    v_mfma_f32_32x32x16_bf16 v[80:95], v[36:39], v[20:23], v[80:95]
    v_mfma_f32_32x32x16_bf16 v[96:111], v[40:43], v[20:23], v[96:111]
    s_mov_b32 s43, 836608
    s_add_u32 m0, s47, 3072
    s_nop 0
    buffer_load_dwordx4 v4, s[28:31], s43 offen lds
    s_add_u32 m0, s47, 4096
    s_nop 0
    buffer_load_dwordx4 v5, s[28:31], s43 offen lds
    s_add_u32 m0, s47, 5120
    s_nop 0
    buffer_load_dwordx4 v6, s[28:31], s43 offen lds
    buffer_load_dwordx4 v[20:23], v7, s[24:27], 0 offen offset:672
    s_waitcnt vmcnt(5)
    ds_read_b64_tr_b16 v[32:33], v8 offset:0
    ds_read_b64_tr_b16 v[34:35], v8 offset:768
    ds_read_b64_tr_b16 v[36:37], v8 offset:64
    ds_read_b64_tr_b16 v[38:39], v8 offset:832
    ds_read_b64_tr_b16 v[40:41], v8 offset:128
    ds_read_b64_tr_b16 v[42:43], v8 offset:896
    s_waitcnt lgkmcnt(0)
    v_mfma_f32_32x32x16_bf16 v[64:79], v[32:35], v[24:27], v[64:79]
    v_mfma_f32_32x32x16_bf16 v[80:95], v[36:39], v[24:27], v[80:95]
    v_mfma_f32_32x32x16_bf16 v[96:111], v[40:43], v[24:27], v[96:111]
    s_mov_b32 s43, 880640
    s_add_u32 m0, s47, 0
    s_nop 0
    buffer_load_dwordx4 v4, s[28:31], s43 offen lds
    s_add_u32 m0, s47, 1024
    s_nop 0
    buffer_load_dwordx4 v5, s[28:31], s43 offen lds
    s_add_u32 m0, s47, 2048
    s_nop 0
    buffer_load_dwordx4 v6, s[28:31], s43 offen lds
    buffer_load_dwordx4 v[24:27], v7, s[24:27], 0 offen offset:704
    s_waitcnt vmcnt(5)
    ds_read_b64_tr_b16 v[32:33], v8 offset:3072
    ds_read_b64_tr_b16 v[34:35], v8 offset:3840
    ds_read_b64_tr_b16 v[36:37], v8 offset:3136
    ds_read_b64_tr_b16 v[38:39], v8 offset:3904
    ds_read_b64_tr_b16 v[40:41], v8 offset:3200
    ds_read_b64_tr_b16 v[42:43], v8 offset:3968
    s_waitcnt lgkmcnt(0)
    v_mfma_f32_32x32x16_bf16 v[64:79], v[32:35], v[28:31], v[64:79]
    v_mfma_f32_32x32x16_bf16 v[80:95], v[36:39], v[28:31], v[80:95]
    v_mfma_f32_32x32x16_bf16 v[96:111], v[40:43], v[28:31], v[96:111]
    s_mov_b32 s43, 924672
    s_add_u32 m0, s47, 3072
    s_nop 0
    buffer_load_dwordx4 v4, s[28:31], s43 offen lds
    s_add_u32 m0, s47, 4096
    s_nop 0
    buffer_load_dwordx4 v5, s[28:31], s43 offen lds
    s_add_u32 m0, s47, 5120
    s_nop 0
    buffer_load_dwordx4 v6, s[28:31], s43 offen lds
    buffer_load_dwordx4 v[28:31], v7, s[24:27], 0 offen offset:736
    s_waitcnt vmcnt(5)
    ds_read_b64_tr_b16 v[32:33], v8 offset:0
    ds_read_b64_tr_b16 v[34:35], v8 offset:768
    ds_read_b64_tr_b16 v[36:37], v8 offset:64
    ds_read_b64_tr_b16 v[38:39], v8 offset:832
    ds_read_b64_tr_b16 v[40:41], v8 offset:128
    ds_read_b64_tr_b16 v[42:43], v8 offset:896
    s_waitcnt lgkmcnt(0)
    v_mfma_f32_32x32x16_bf16 v[64:79], v[32:35], v[16:19], v[64:79]
    v_mfma_f32_32x32x16_bf16 v[80:95], v[36:39], v[16:19], v[80:95]
    v_mfma_f32_32x32x16_bf16 v[96:111], v[40:43], v[16:19], v[96:111]
    s_mov_b32 s43, 968704
    s_add_u32 m0, s47, 0
    s_nop 0
    buffer_load_dwordx4 v4, s[28:31], s43 offen lds
    s_add_u32 m0, s47, 1024
    s_nop 0
    buffer_load_dwordx4 v5, s[28:31], s43 offen lds
    s_add_u32 m0, s47, 2048
    s_nop 0
    buffer_load_dwordx4 v6, s[28:31], s43 offen lds
    buffer_load_dwordx4 v[16:19], v7, s[24:27], 0 offen offset:768
    s_waitcnt vmcnt(5)
    ds_read_b64_tr_b16 v[32:33], v8 offset:3072
    ds_read_b64_tr_b16 v[34:35], v8 offset:3840
    ds_read_b64_tr_b16 v[36:37], v8 offset:3136
    ds_read_b64_tr_b16 v[38:39], v8 offset:3904
    ds_read_b64_tr_b16 v[40:41], v8 offset:3200
    ds_read_b64_tr_b16 v[42:43], v8 offset:3968
    s_waitcnt lgkmcnt(0)
    v_mfma_f32_32x32x16_bf16 v[64:79], v[32:35], v[20:23], v[64:79]
    v_mfma_f32_32x32x16_bf16 v[80:95], v[36:39], v[20:23], v[80:95]
    v_mfma_f32_32x32x16_bf16 v[96:111], v[40:43], v[20:23], v[96:111]
    s_mov_b32 s43, 1012736
    s_add_u32 m0, s47, 3072
    s_nop 0
    buffer_load_dwordx4 v4, s[28:31], s43 offen lds
    s_add_u32 m0, s47, 4096
    s_nop 0
    buffer_load_dwordx4 v5, s[28:31], s43 offen lds
    s_add_u32 m0, s47, 5120
    s_nop 0
    buffer_load_dwordx4 v6, s[28:31], s43 offen lds
    buffer_load_dwordx4 v[20:23], v7, s[24:27], 0 offen offset:800
    s_waitcnt vmcnt(5)
    ds_read_b64_tr_b16 v[32:33], v8 offset:0
    ds_read_b64_tr_b16 v[34:35], v8 offset:768
    ds_read_b64_tr_b16 v[36:37], v8 offset:64
    ds_read_b64_tr_b16 v[38:39], v8 offset:832
    ds_read_b64_tr_b16 v[40:41], v8 offset:128
    ds_read_b64_tr_b16 v[42:43], v8 offset:896
    s_waitcnt lgkmcnt(0)
    v_mfma_f32_32x32x16_bf16 v[64:79], v[32:35], v[24:27], v[64:79]
    v_mfma_f32_32x32x16_bf16 v[80:95], v[36:39], v[24:27], v[80:95]
    v_mfma_f32_32x32x16_bf16 v[96:111], v[40:43], v[24:27], v[96:111]
    s_mov_b32 s43, 1056768
    s_add_u32 m0, s47, 0
    s_nop 0
    buffer_load_dwordx4 v4, s[28:31], s43 offen lds
    s_add_u32 m0, s47, 1024
    s_nop 0
    buffer_load_dwordx4 v5, s[28:31], s43 offen lds
    s_add_u32 m0, s47, 2048
    s_nop 0
    buffer_load_dwordx4 v6, s[28:31], s43 offen lds
    buffer_load_dwordx4 v[24:27], v7, s[24:27], 0 offen offset:832
    s_waitcnt vmcnt(5)
    ds_read_b64_tr_b16 v[32:33], v8 offset:3072
    ds_read_b64_tr_b16 v[34:35], v8 offset:3840
    ds_read_b64_tr_b16 v[36:37], v8 offset:3136
    ds_read_b64_tr_b16 v[38:39], v8 offset:3904
    ds_read_b64_tr_b16 v[40:41], v8 offset:3200
    ds_read_b64_tr_b16 v[42:43], v8 offset:3968
    s_waitcnt lgkmcnt(0)
    v_mfma_f32_32x32x16_bf16 v[64:79], v[32:35], v[28:31], v[64:79]
    v_mfma_f32_32x32x16_bf16 v[80:95], v[36:39], v[28:31], v[80:95]
    v_mfma_f32_32x32x16_bf16 v[96:111], v[40:43], v[28:31], v[96:111]
    s_mov_b32 s43, 1100800
    s_add_u32 m0, s47, 3072
    s_nop 0
    buffer_load_dwordx4 v4, s[28:31], s43 offen lds
    s_add_u32 m0, s47, 4096
    s_nop 0
    buffer_load_dwordx4 v5, s[28:31], s43 offen lds
    s_add_u32 m0, s47, 5120
    s_nop 0
    buffer_load_dwordx4 v6, s[28:31], s43 offen lds
    buffer_load_dwordx4 v[28:31], v7, s[24:27], 0 offen offset:864
    s_waitcnt vmcnt(5)
    ds_read_b64_tr_b16 v[32:33], v8 offset:0
    ds_read_b64_tr_b16 v[34:35], v8 offset:768
    ds_read_b64_tr_b16 v[36:37], v8 offset:64
    ds_read_b64_tr_b16 v[38:39], v8 offset:832
    ds_read_b64_tr_b16 v[40:41], v8 offset:128
    ds_read_b64_tr_b16 v[42:43], v8 offset:896
    s_waitcnt lgkmcnt(0)
    v_mfma_f32_32x32x16_bf16 v[64:79], v[32:35], v[16:19], v[64:79]
    v_mfma_f32_32x32x16_bf16 v[80:95], v[36:39], v[16:19], v[80:95]
    v_mfma_f32_32x32x16_bf16 v[96:111], v[40:43], v[16:19], v[96:111]
    s_mov_b32 s43, 1144832
    s_add_u32 m0, s47, 0
    s_nop 0
    buffer_load_dwordx4 v4, s[28:31], s43 offen lds
    s_add_u32 m0, s47, 1024
    s_nop 0
    buffer_load_dwordx4 v5, s[28:31], s43 offen lds
    s_add_u32 m0, s47, 2048
    s_nop 0
    buffer_load_dwordx4 v6, s[28:31], s43 offen lds
    buffer_load_dwordx4 v[16:19], v7, s[24:27], 0 offen offset:896
    s_waitcnt vmcnt(5)
    ds_read_b64_tr_b16 v[32:33], v8 offset:3072
    ds_read_b64_tr_b16 v[34:35], v8 offset:3840
    ds_read_b64_tr_b16 v[36:37], v8 offset:3136
    ds_read_b64_tr_b16 v[38:39], v8 offset:3904
    ds_read_b64_tr_b16 v[40:41], v8 offset:3200
    ds_read_b64_tr_b16 v[42:43], v8 offset:3968
    s_waitcnt lgkmcnt(0)
    v_mfma_f32_32x32x16_bf16 v[64:79], v[32:35], v[20:23], v[64:79]
    v_mfma_f32_32x32x16_bf16 v[80:95], v[36:39], v[20:23], v[80:95]
    v_mfma_f32_32x32x16_bf16 v[96:111], v[40:43], v[20:23], v[96:111]
    s_mov_b32 s43, 1188864
    s_add_u32 m0, s47, 3072
    s_nop 0
    buffer_load_dwordx4 v4, s[28:31], s43 offen lds
    s_add_u32 m0, s47, 4096
    s_nop 0
    buffer_load_dwordx4 v5, s[28:31], s43 offen lds
    s_add_u32 m0, s47, 5120
    s_nop 0
    buffer_load_dwordx4 v6, s[28:31], s43 offen lds
    buffer_load_dwordx4 v[20:23], v7, s[24:27], 0 offen offset:928
    s_waitcnt vmcnt(5)
    ds_read_b64_tr_b16 v[32:33], v8 offset:0
    ds_read_b64_tr_b16 v[34:35], v8 offset:768
    ds_read_b64_tr_b16 v[36:37], v8 offset:64
    ds_read_b64_tr_b16 v[38:39], v8 offset:832
    ds_read_b64_tr_b16 v[40:41], v8 offset:128
    ds_read_b64_tr_b16 v[42:43], v8 offset:896
    s_waitcnt lgkmcnt(0)
    v_mfma_f32_32x32x16_bf16 v[64:79], v[32:35], v[24:27], v[64:79]
    v_mfma_f32_32x32x16_bf16 v[80:95], v[36:39], v[24:27], v[80:95]
    v_mfma_f32_32x32x16_bf16 v[96:111], v[40:43], v[24:27], v[96:111]
    s_mov_b32 s43, 1232896
    s_add_u32 m0, s47, 0
    s_nop 0
    buffer_load_dwordx4 v4, s[28:31], s43 offen lds
    s_add_u32 m0, s47, 1024
    s_nop 0
    buffer_load_dwordx4 v5, s[28:31], s43 offen lds
    s_add_u32 m0, s47, 2048
    s_nop 0
    buffer_load_dwordx4 v6, s[28:31], s43 offen lds
    buffer_load_dwordx4 v[24:27], v7, s[24:27], 0 offen offset:960
    s_waitcnt vmcnt(5)
    ds_read_b64_tr_b16 v[32:33], v8 offset:3072
    ds_read_b64_tr_b16 v[34:35], v8 offset:3840
    ds_read_b64_tr_b16 v[36:37], v8 offset:3136
    ds_read_b64_tr_b16 v[38:39], v8 offset:3904
    ds_read_b64_tr_b16 v[40:41], v8 offset:3200
    ds_read_b64_tr_b16 v[42:43], v8 offset:3968
    s_waitcnt lgkmcnt(0)
    v_mfma_f32_32x32x16_bf16 v[64:79], v[32:35], v[28:31], v[64:79]
    v_mfma_f32_32x32x16_bf16 v[80:95], v[36:39], v[28:31], v[80:95]
    v_mfma_f32_32x32x16_bf16 v[96:111], v[40:43], v[28:31], v[96:111]
    s_mov_b32 s43, 1276928
    s_add_u32 m0, s47, 3072
    s_nop 0
    buffer_load_dwordx4 v4, s[28:31], s43 offen lds
    s_add_u32 m0, s47, 4096
    s_nop 0
    buffer_load_dwordx4 v5, s[28:31], s43 offen lds
    s_add_u32 m0, s47, 5120
    s_nop 0
    buffer_load_dwordx4 v6, s[28:31], s43 offen lds
    buffer_load_dwordx4 v[28:31], v7, s[24:27], 0 offen offset:992
    s_waitcnt vmcnt(5)
    ds_read_b64_tr_b16 v[32:33], v8 offset:0
    ds_read_b64_tr_b16 v[34:35], v8 offset:768
    ds_read_b64_tr_b16 v[36:37], v8 offset:64
    ds_read_b64_tr_b16 v[38:39], v8 offset:832
    ds_read_b64_tr_b16 v[40:41], v8 offset:128
    ds_read_b64_tr_b16 v[42:43], v8 offset:896
    s_waitcnt lgkmcnt(0)
    v_mfma_f32_32x32x16_bf16 v[64:79], v[32:35], v[16:19], v[64:79]
    v_mfma_f32_32x32x16_bf16 v[80:95], v[36:39], v[16:19], v[80:95]
    v_mfma_f32_32x32x16_bf16 v[96:111], v[40:43], v[16:19], v[96:111]
    s_mov_b32 s43, 1320960
    s_add_u32 m0, s47, 0
    s_nop 0
    buffer_load_dwordx4 v4, s[28:31], s43 offen lds
    s_add_u32 m0, s47, 1024
    s_nop 0
    buffer_load_dwordx4 v5, s[28:31], s43 offen lds
    s_add_u32 m0, s47, 2048
    s_nop 0
    buffer_load_dwordx4 v6, s[28:31], s43 offen lds
    s_waitcnt vmcnt(4)
    ds_read_b64_tr_b16 v[32:33], v8 offset:3072
    ds_read_b64_tr_b16 v[34:35], v8 offset:3840
    ds_read_b64_tr_b16 v[36:37], v8 offset:3136
    ds_read_b64_tr_b16 v[38:39], v8 offset:3904
    ds_read_b64_tr_b16 v[40:41], v8 offset:3200
    ds_read_b64_tr_b16 v[42:43], v8 offset:3968
    s_waitcnt lgkmcnt(0)
    v_mfma_f32_32x32x16_bf16 v[64:79], v[32:35], v[20:23], v[64:79]
    v_mfma_f32_32x32x16_bf16 v[80:95], v[36:39], v[20:23], v[80:95]
    v_mfma_f32_32x32x16_bf16 v[96:111], v[40:43], v[20:23], v[96:111]
    s_mov_b32 s43, 1364992
    s_add_u32 m0, s47, 3072
    s_nop 0
    buffer_load_dwordx4 v4, s[28:31], s43 offen lds
    s_add_u32 m0, s47, 4096
    s_nop 0
    buffer_load_dwordx4 v5, s[28:31], s43 offen lds
    s_add_u32 m0, s47, 5120
    s_nop 0
    buffer_load_dwordx4 v6, s[28:31], s43 offen lds
    s_waitcnt vmcnt(3)
    ds_read_b64_tr_b16 v[32:33], v8 offset:0
    ds_read_b64_tr_b16 v[34:35], v8 offset:768
    ds_read_b64_tr_b16 v[36:37], v8 offset:64
    ds_read_b64_tr_b16 v[38:39], v8 offset:832
    ds_read_b64_tr_b16 v[40:41], v8 offset:128
    ds_read_b64_tr_b16 v[42:43], v8 offset:896
    s_waitcnt lgkmcnt(0)
    v_mfma_f32_32x32x16_bf16 v[64:79], v[32:35], v[24:27], v[64:79]
    v_mfma_f32_32x32x16_bf16 v[80:95], v[36:39], v[24:27], v[80:95]
    v_mfma_f32_32x32x16_bf16 v[96:111], v[40:43], v[24:27], v[96:111]
    s_waitcnt vmcnt(0)
    ds_read_b64_tr_b16 v[32:33], v8 offset:3072
    ds_read_b64_tr_b16 v[34:35], v8 offset:3840
    ds_read_b64_tr_b16 v[36:37], v8 offset:3136
    ds_read_b64_tr_b16 v[38:39], v8 offset:3904
    ds_read_b64_tr_b16 v[40:41], v8 offset:3200
    ds_read_b64_tr_b16 v[42:43], v8 offset:3968
    s_waitcnt lgkmcnt(0)
    v_mfma_f32_32x32x16_bf16 v[64:79], v[32:35], v[28:31], v[64:79]
    v_mfma_f32_32x32x16_bf16 v[80:95], v[36:39], v[28:31], v[80:95]
    v_mfma_f32_32x32x16_bf16 v[96:111], v[40:43], v[28:31], v[96:111]
    v_cmp_gt_u32 vcc, 32, v1
    v_mov_b32 v44, 0x3f80
    v_mov_b32 v45, 0
    v_mov_b32 v46, 0
    v_mov_b32 v47, 0
    v_cndmask_b32 v44, 0, v44, vcc
    v_mov_b32 v49, 0
    v_mov_b32 v50, 0
    v_mov_b32 v51, 0
    v_mov_b32 v48, v9
    v_mov_b32 v53, 0
    v_mov_b32 v54, 0
    v_mov_b32 v55, 0
    v_mov_b32 v52, v10
    v_mov_b32 v57, 0
    v_mov_b32 v58, 0
    v_mov_b32 v59, 0
    v_mov_b32 v56, v11
    s_nop 1
    v_mfma_f32_32x32x16_bf16 v[64:79], v[48:51], v[44:47], v[64:79]
    v_mfma_f32_32x32x16_bf16 v[80:95], v[52:55], v[44:47], v[80:95]
    v_mfma_f32_32x32x16_bf16 v[96:111], v[56:59], v[44:47], v[96:111]
    v_and_b32 v2, 31, v1
    v_lshrrev_b32 v3, 5, v1
    v_add_u32 v12, s46, v2
    v_mul_u32_u24 v12, 2752, v12
    v_lshl_add_u32 v12, v3, 4, v12
    s_mov_b32 s60, 0x3fb8aa3b
    s_mov_b32 s61, s60
    s_mov_b32 s62, 2.0
    s_mov_b32 s63, 2.0
    s_nop 15
    s_add_u32 s43, s45, 0
    s_cmp_ge_u32 s43, 1376
    s_cbranch_scc1 K2_END
    s_lshl_b32 s43, s43, 1
    s_add_u32 s43, s43, 8388608
    v_pk_mul_f32 v[112:113], v[64:65], s[60:61]
    v_pk_mul_f32 v[114:115], v[66:67], s[60:61]
    v_pk_mul_f32 v[116:117], v[68:69], s[60:61]
    v_pk_mul_f32 v[118:119], v[70:71], s[60:61]
    v_pk_mul_f32 v[120:121], v[72:73], s[60:61]
    v_pk_mul_f32 v[122:123], v[74:75], s[60:61]
    v_pk_mul_f32 v[124:125], v[76:77], s[60:61]
    v_pk_mul_f32 v[126:127], v[78:79], s[60:61]
    v_min_f32 v112, 0x42200000, v112
    v_min_f32 v113, 0x42200000, v113
    v_min_f32 v114, 0x42200000, v114
    v_min_f32 v115, 0x42200000, v115
    v_min_f32 v116, 0x42200000, v116
    v_min_f32 v117, 0x42200000, v117
    v_min_f32 v118, 0x42200000, v118
    v_min_f32 v119, 0x42200000, v119
    v_min_f32 v120, 0x42200000, v120
    v_min_f32 v121, 0x42200000, v121
    v_min_f32 v122, 0x42200000, v122
    v_min_f32 v123, 0x42200000, v123
    v_min_f32 v124, 0x42200000, v124
    v_min_f32 v125, 0x42200000, v125
    v_min_f32 v126, 0x42200000, v126
    v_min_f32 v127, 0x42200000, v127
    v_exp_f32 v112, v112
    v_exp_f32 v113, v113
    v_exp_f32 v114, v114
    v_exp_f32 v115, v115
    v_exp_f32 v116, v116
    v_exp_f32 v117, v117
    v_exp_f32 v118, v118
    v_exp_f32 v119, v119
    v_exp_f32 v120, v120
    v_exp_f32 v121, v121
    v_exp_f32 v122, v122
    v_exp_f32 v123, v123
    v_exp_f32 v124, v124
    v_exp_f32 v125, v125
    v_exp_f32 v126, v126
    v_exp_f32 v127, v127
    v_pk_add_f32 v[44:45], v[112:113], s[62:63]
    v_pk_add_f32 v[46:47], v[114:115], s[62:63]
    v_pk_add_f32 v[48:49], v[116:117], s[62:63]
    v_pk_add_f32 v[50:51], v[118:119], s[62:63]
    v_pk_add_f32 v[52:53], v[120:121], s[62:63]
    v_pk_add_f32 v[54:55], v[122:123], s[62:63]
    v_pk_add_f32 v[56:57], v[124:125], s[62:63]
    v_pk_add_f32 v[58:59], v[126:127], s[62:63]
    v_pk_mul_f32 v[112:113], v[112:113], v[44:45]
    v_pk_mul_f32 v[114:115], v[114:115], v[46:47]
    v_pk_mul_f32 v[116:117], v[116:117], v[48:49]
    v_pk_mul_f32 v[118:119], v[118:119], v[50:51]
    v_pk_mul_f32 v[120:121], v[120:121], v[52:53]
    v_pk_mul_f32 v[122:123], v[122:123], v[54:55]
    v_pk_mul_f32 v[124:125], v[124:125], v[56:57]
    v_pk_mul_f32 v[126:127], v[126:127], v[58:59]
    v_pk_add_f32 v[44:45], v[112:113], s[62:63]
    v_pk_add_f32 v[46:47], v[114:115], s[62:63]
    v_pk_add_f32 v[48:49], v[116:117], s[62:63]
    v_pk_add_f32 v[50:51], v[118:119], s[62:63]
    v_pk_add_f32 v[52:53], v[120:121], s[62:63]
    v_pk_add_f32 v[54:55], v[122:123], s[62:63]
    v_pk_add_f32 v[56:57], v[124:125], s[62:63]
    v_pk_add_f32 v[58:59], v[126:127], s[62:63]
    v_rcp_f32 v44, v44
    v_rcp_f32 v45, v45
    v_rcp_f32 v46, v46
    v_rcp_f32 v47, v47
    v_rcp_f32 v48, v48
    v_rcp_f32 v49, v49
    v_rcp_f32 v50, v50
    v_rcp_f32 v51, v51
    v_rcp_f32 v52, v52
    v_rcp_f32 v53, v53
    v_rcp_f32 v54, v54
    v_rcp_f32 v55, v55
    v_rcp_f32 v56, v56
    v_rcp_f32 v57, v57
    v_rcp_f32 v58, v58
    v_rcp_f32 v59, v59
    v_pk_mul_f32 v[112:113], v[112:113], v[64:65]
    v_pk_mul_f32 v[114:115], v[114:115], v[66:67]
    v_pk_mul_f32 v[116:117], v[116:117], v[68:69]
    v_pk_mul_f32 v[118:119], v[118:119], v[70:71]
    v_pk_mul_f32 v[120:121], v[120:121], v[72:73]
    v_pk_mul_f32 v[122:123], v[122:123], v[74:75]
    v_pk_mul_f32 v[124:125], v[124:125], v[76:77]
    v_pk_mul_f32 v[126:127], v[126:127], v[78:79]
    v_pk_mul_f32 v[112:113], v[112:113], v[44:45]
    v_pk_mul_f32 v[114:115], v[114:115], v[46:47]
    v_pk_mul_f32 v[116:117], v[116:117], v[48:49]
    v_pk_mul_f32 v[118:119], v[118:119], v[50:51]
    v_pk_mul_f32 v[120:121], v[120:121], v[52:53]
    v_pk_mul_f32 v[122:123], v[122:123], v[54:55]
    v_pk_mul_f32 v[124:125], v[124:125], v[56:57]
    v_pk_mul_f32 v[126:127], v[126:127], v[58:59]
    v_cvt_pk_bf16_f32 v44, v112, v113
    v_cvt_pk_bf16_f32 v45, v114, v115
    v_cvt_pk_bf16_f32 v46, v116, v117
    v_cvt_pk_bf16_f32 v47, v118, v119
    v_cvt_pk_bf16_f32 v48, v120, v121
    v_cvt_pk_bf16_f32 v49, v122, v123
    v_cvt_pk_bf16_f32 v50, v124, v125
    v_cvt_pk_bf16_f32 v51, v126, v127
    buffer_store_dwordx4 v[44:47], v12, s[20:23], s43 offen
    buffer_store_dwordx4 v[48:51], v12, s[20:23], s43 offen offset:32
    s_nop 1
    s_add_u32 s43, s45, 32
    s_cmp_ge_u32 s43, 1376
    s_cbranch_scc1 K2_END
    s_lshl_b32 s43, s43, 1
    s_add_u32 s43, s43, 8388608
    v_pk_mul_f32 v[112:113], v[80:81], s[60:61]
    v_pk_mul_f32 v[114:115], v[82:83], s[60:61]
    v_pk_mul_f32 v[116:117], v[84:85], s[60:61]
    v_pk_mul_f32 v[118:119], v[86:87], s[60:61]
    v_pk_mul_f32 v[120:121], v[88:89], s[60:61]
    v_pk_mul_f32 v[122:123], v[90:91], s[60:61]
    v_pk_mul_f32 v[124:125], v[92:93], s[60:61]
    v_pk_mul_f32 v[126:127], v[94:95], s[60:61]
    v_min_f32 v112, 0x42200000, v112
    v_min_f32 v113, 0x42200000, v113
    v_min_f32 v114, 0x42200000, v114
    v_min_f32 v115, 0x42200000, v115
    v_min_f32 v116, 0x42200000, v116
    v_min_f32 v117, 0x42200000, v117
    v_min_f32 v118, 0x42200000, v118
    v_min_f32 v119, 0x42200000, v119
    v_min_f32 v120, 0x42200000, v120
    v_min_f32 v121, 0x42200000, v121
    v_min_f32 v122, 0x42200000, v122
    v_min_f32 v123, 0x42200000, v123
    v_min_f32 v124, 0x42200000, v124
    v_min_f32 v125, 0x42200000, v125
    v_min_f32 v126, 0x42200000, v126
    v_min_f32 v127, 0x42200000, v127
    v_exp_f32 v112, v112
    v_exp_f32 v113, v113
    v_exp_f32 v114, v114
    v_exp_f32 v115, v115
    v_exp_f32 v116, v116
    v_exp_f32 v117, v117
    v_exp_f32 v118, v118
    v_exp_f32 v119, v119
    v_exp_f32 v120, v120
    v_exp_f32 v121, v121
    v_exp_f32 v122, v122
    v_exp_f32 v123, v123
    v_exp_f32 v124, v124
    v_exp_f32 v125, v125
    v_exp_f32 v126, v126
    v_exp_f32 v127, v127
    v_pk_add_f32 v[44:45], v[112:113], s[62:63]
    v_pk_add_f32 v[46:47], v[114:115], s[62:63]
    v_pk_add_f32 v[48:49], v[116:117], s[62:63]
    v_pk_add_f32 v[50:51], v[118:119], s[62:63]
    v_pk_add_f32 v[52:53], v[120:121], s[62:63]
    v_pk_add_f32 v[54:55], v[122:123], s[62:63]
    v_pk_add_f32 v[56:57], v[124:125], s[62:63]
    v_pk_add_f32 v[58:59], v[126:127], s[62:63]
    v_pk_mul_f32 v[112:113], v[112:113], v[44:45]
    v_pk_mul_f32 v[114:115], v[114:115], v[46:47]
    v_pk_mul_f32 v[116:117], v[116:117], v[48:49]
    v_pk_mul_f32 v[118:119], v[118:119], v[50:51]
    v_pk_mul_f32 v[120:121], v[120:121], v[52:53]
    v_pk_mul_f32 v[122:123], v[122:123], v[54:55]
    v_pk_mul_f32 v[124:125], v[124:125], v[56:57]
    v_pk_mul_f32 v[126:127], v[126:127], v[58:59]
    v_pk_add_f32 v[44:45], v[112:113], s[62:63]
    v_pk_add_f32 v[46:47], v[114:115], s[62:63]
    v_pk_add_f32 v[48:49], v[116:117], s[62:63]
    v_pk_add_f32 v[50:51], v[118:119], s[62:63]
    v_pk_add_f32 v[52:53], v[120:121], s[62:63]
    v_pk_add_f32 v[54:55], v[122:123], s[62:63]
    v_pk_add_f32 v[56:57], v[124:125], s[62:63]
    v_pk_add_f32 v[58:59], v[126:127], s[62:63]
    v_rcp_f32 v44, v44
    v_rcp_f32 v45, v45
    v_rcp_f32 v46, v46
    v_rcp_f32 v47, v47
    v_rcp_f32 v48, v48
    v_rcp_f32 v49, v49
    v_rcp_f32 v50, v50
    v_rcp_f32 v51, v51
    v_rcp_f32 v52, v52
    v_rcp_f32 v53, v53
    v_rcp_f32 v54, v54
    v_rcp_f32 v55, v55
    v_rcp_f32 v56, v56
    v_rcp_f32 v57, v57
    v_rcp_f32 v58, v58
    v_rcp_f32 v59, v59
    v_pk_mul_f32 v[112:113], v[112:113], v[80:81]
    v_pk_mul_f32 v[114:115], v[114:115], v[82:83]
    v_pk_mul_f32 v[116:117], v[116:117], v[84:85]
    v_pk_mul_f32 v[118:119], v[118:119], v[86:87]
    v_pk_mul_f32 v[120:121], v[120:121], v[88:89]
    v_pk_mul_f32 v[122:123], v[122:123], v[90:91]
    v_pk_mul_f32 v[124:125], v[124:125], v[92:93]
    v_pk_mul_f32 v[126:127], v[126:127], v[94:95]
    v_pk_mul_f32 v[112:113], v[112:113], v[44:45]
    v_pk_mul_f32 v[114:115], v[114:115], v[46:47]
    v_pk_mul_f32 v[116:117], v[116:117], v[48:49]
    v_pk_mul_f32 v[118:119], v[118:119], v[50:51]
    v_pk_mul_f32 v[120:121], v[120:121], v[52:53]
    v_pk_mul_f32 v[122:123], v[122:123], v[54:55]
    v_pk_mul_f32 v[124:125], v[124:125], v[56:57]
    v_pk_mul_f32 v[126:127], v[126:127], v[58:59]
    v_cvt_pk_bf16_f32 v44, v112, v113
    v_cvt_pk_bf16_f32 v45, v114, v115
    v_cvt_pk_bf16_f32 v46, v116, v117
    v_cvt_pk_bf16_f32 v47, v118, v119
    v_cvt_pk_bf16_f32 v48, v120, v121
    v_cvt_pk_bf16_f32 v49, v122, v123
    v_cvt_pk_bf16_f32 v50, v124, v125
    v_cvt_pk_bf16_f32 v51, v126, v127
    buffer_store_dwordx4 v[44:47], v12, s[20:23], s43 offen
    buffer_store_dwordx4 v[48:51], v12, s[20:23], s43 offen offset:32
    s_nop 1
    s_add_u32 s43, s45, 64
    s_cmp_ge_u32 s43, 1376
    s_cbranch_scc1 K2_END
    s_lshl_b32 s43, s43, 1
    s_add_u32 s43, s43, 8388608
    v_pk_mul_f32 v[112:113], v[96:97], s[60:61]
    v_pk_mul_f32 v[114:115], v[98:99], s[60:61]
    v_pk_mul_f32 v[116:117], v[100:101], s[60:61]
    v_pk_mul_f32 v[118:119], v[102:103], s[60:61]
    v_pk_mul_f32 v[120:121], v[104:105], s[60:61]
    v_pk_mul_f32 v[122:123], v[106:107], s[60:61]
    v_pk_mul_f32 v[124:125], v[108:109], s[60:61]
    v_pk_mul_f32 v[126:127], v[110:111], s[60:61]
    v_min_f32 v112, 0x42200000, v112
    v_min_f32 v113, 0x42200000, v113
    v_min_f32 v114, 0x42200000, v114
    v_min_f32 v115, 0x42200000, v115
    v_min_f32 v116, 0x42200000, v116
    v_min_f32 v117, 0x42200000, v117
    v_min_f32 v118, 0x42200000, v118
    v_min_f32 v119, 0x42200000, v119
    v_min_f32 v120, 0x42200000, v120
    v_min_f32 v121, 0x42200000, v121
    v_min_f32 v122, 0x42200000, v122
    v_min_f32 v123, 0x42200000, v123
    v_min_f32 v124, 0x42200000, v124
    v_min_f32 v125, 0x42200000, v125
    v_min_f32 v126, 0x42200000, v126
    v_min_f32 v127, 0x42200000, v127
    v_exp_f32 v112, v112
    v_exp_f32 v113, v113
    v_exp_f32 v114, v114
    v_exp_f32 v115, v115
    v_exp_f32 v116, v116
    v_exp_f32 v117, v117
    v_exp_f32 v118, v118
    v_exp_f32 v119, v119
    v_exp_f32 v120, v120
    v_exp_f32 v121, v121
    v_exp_f32 v122, v122
    v_exp_f32 v123, v123
    v_exp_f32 v124, v124
    v_exp_f32 v125, v125
    v_exp_f32 v126, v126
    v_exp_f32 v127, v127
    v_pk_add_f32 v[44:45], v[112:113], s[62:63]
    v_pk_add_f32 v[46:47], v[114:115], s[62:63]
    v_pk_add_f32 v[48:49], v[116:117], s[62:63]
    v_pk_add_f32 v[50:51], v[118:119], s[62:63]
    v_pk_add_f32 v[52:53], v[120:121], s[62:63]
    v_pk_add_f32 v[54:55], v[122:123], s[62:63]
    v_pk_add_f32 v[56:57], v[124:125], s[62:63]
    v_pk_add_f32 v[58:59], v[126:127], s[62:63]
    v_pk_mul_f32 v[112:113], v[112:113], v[44:45]
    v_pk_mul_f32 v[114:115], v[114:115], v[46:47]
    v_pk_mul_f32 v[116:117], v[116:117], v[48:49]
    v_pk_mul_f32 v[118:119], v[118:119], v[50:51]
    v_pk_mul_f32 v[120:121], v[120:121], v[52:53]
    v_pk_mul_f32 v[122:123], v[122:123], v[54:55]
    v_pk_mul_f32 v[124:125], v[124:125], v[56:57]
    v_pk_mul_f32 v[126:127], v[126:127], v[58:59]
    v_pk_add_f32 v[44:45], v[112:113], s[62:63]
    v_pk_add_f32 v[46:47], v[114:115], s[62:63]
    v_pk_add_f32 v[48:49], v[116:117], s[62:63]
    v_pk_add_f32 v[50:51], v[118:119], s[62:63]
    v_pk_add_f32 v[52:53], v[120:121], s[62:63]
    v_pk_add_f32 v[54:55], v[122:123], s[62:63]
    v_pk_add_f32 v[56:57], v[124:125], s[62:63]
    v_pk_add_f32 v[58:59], v[126:127], s[62:63]
    v_rcp_f32 v44, v44
    v_rcp_f32 v45, v45
    v_rcp_f32 v46, v46
    v_rcp_f32 v47, v47
    v_rcp_f32 v48, v48
    v_rcp_f32 v49, v49
    v_rcp_f32 v50, v50
    v_rcp_f32 v51, v51
    v_rcp_f32 v52, v52
    v_rcp_f32 v53, v53
    v_rcp_f32 v54, v54
    v_rcp_f32 v55, v55
    v_rcp_f32 v56, v56
    v_rcp_f32 v57, v57
    v_rcp_f32 v58, v58
    v_rcp_f32 v59, v59
    v_pk_mul_f32 v[112:113], v[112:113], v[96:97]
    v_pk_mul_f32 v[114:115], v[114:115], v[98:99]
    v_pk_mul_f32 v[116:117], v[116:117], v[100:101]
    v_pk_mul_f32 v[118:119], v[118:119], v[102:103]
    v_pk_mul_f32 v[120:121], v[120:121], v[104:105]
    v_pk_mul_f32 v[122:123], v[122:123], v[106:107]
    v_pk_mul_f32 v[124:125], v[124:125], v[108:109]
    v_pk_mul_f32 v[126:127], v[126:127], v[110:111]
    v_pk_mul_f32 v[112:113], v[112:113], v[44:45]
    v_pk_mul_f32 v[114:115], v[114:115], v[46:47]
    v_pk_mul_f32 v[116:117], v[116:117], v[48:49]
    v_pk_mul_f32 v[118:119], v[118:119], v[50:51]
    v_pk_mul_f32 v[120:121], v[120:121], v[52:53]
    v_pk_mul_f32 v[122:123], v[122:123], v[54:55]
    v_pk_mul_f32 v[124:125], v[124:125], v[56:57]
    v_pk_mul_f32 v[126:127], v[126:127], v[58:59]
    v_cvt_pk_bf16_f32 v44, v112, v113
    v_cvt_pk_bf16_f32 v45, v114, v115
    v_cvt_pk_bf16_f32 v46, v116, v117
    v_cvt_pk_bf16_f32 v47, v118, v119
    v_cvt_pk_bf16_f32 v48, v120, v121
    v_cvt_pk_bf16_f32 v49, v122, v123
    v_cvt_pk_bf16_f32 v50, v124, v125
    v_cvt_pk_bf16_f32 v51, v126, v127
    buffer_store_dwordx4 v[44:47], v12, s[20:23], s43 offen
    buffer_store_dwordx4 v[48:51], v12, s[20:23], s43 offen offset:32
    s_nop 1
    s_branch K2_END
.globl k3_out_kernel
.p2align 8
.type k3_out_kernel,@function
k3_out_kernel:
    s_cmp_ge_u32 s2, 256
    s_cbranch_scc1 K3_END
    s_load_dwordx2 s[4:5], s[0:1], 16
    s_load_dwordx2 s[6:7], s[0:1], 48
    s_load_dwordx2 s[8:9], s[0:1], 64
    s_load_dwordx2 s[14:15], s[0:1], 80
    v_and_b32 v1, 63, v0
    v_lshrrev_b32 v2, 6, v0
    s_nop 0
    v_readfirstlane_b32 s40, v2
    s_and_b32 s43, s2, 7
    s_lshr_b32 s44, s2, 3
    s_lshl_b32 s41, s43, 2
    s_and_b32 s43, s44, 3
    s_add_u32 s41, s41, s43
    s_lshr_b32 s42, s44, 2
    s_lshr_b32 s48, s40, 2
    s_and_b32 s49, s40, 3
    s_lshl_b32 s43, s40, 3
    v_lshrrev_b32 v2, 3, v1
    v_add_u32 v2, s43, v2
    v_lshrrev_b32 v3, 1, v2
    v_and_b32 v3, 7, v3
    v_and_b32 v4, 7, v1
    v_xor_b32 v3, v3, v4
    s_lshl_b32 s43, s41, 6
    v_add_u32 v5, s43, v2
    v_lshlrev_b32 v6, 10, v5
    v_lshl_add_u32 v6, v3, 4, v6
    v_add_u32 v8, 6291456, v6
    v_mul_u32_u24 v6, 2752, v5
    v_lshl_add_u32 v6, v3, 4, v6
    v_add_u32 v9, 8388608, v6
    v_lshlrev_b32 v3, 1, v2
    v_and_b32 v3, 4, v3
    v_xor_b32 v3, v3, v4
    v_lshlrev_b32 v2, 10, v2
    v_lshl_add_u32 v2, v3, 4, v2
    s_lshl_b32 s43, s42, 7
    v_add_u32 v10, s43, v2
    s_lshl_b32 s45, s40, 10
    s_add_u32 s46, s45, 8192
    s_waitcnt lgkmcnt(0)
    s_mov_b32 s20, s14
    s_and_b32 s21, s15, 0xffff
    s_mov_b32 s22, 18874368
    s_mov_b32 s23, 0x00020000
    s_mov_b32 s24, s4
    s_and_b32 s25, s5, 0xffff
    s_mov_b32 s26, 524288
    s_mov_b32 s27, 0x00020000
    s_mov_b32 s28, s6
    s_and_b32 s29, s7, 0xffff
    s_mov_b32 s30, 1409024
    s_mov_b32 s31, 0x00020000
    s_mov_b32 s32, s8
    s_and_b32 s33, s9, 0xffff
    s_mov_b32 s34, 2097152
    s_mov_b32 s35, 0x00020000
    s_mov_b32 s43, 0
    s_add_u32 m0, s45, 0
    s_nop 0
    buffer_load_dwordx4 v8, s[20:23], s43 offen lds
    s_mov_b32 s43, 0
    s_add_u32 m0, s46, 0
    s_nop 0
    buffer_load_dwordx4 v10, s[24:27], s43 offen lds
    s_mov_b32 s43, 128
    s_add_u32 m0, s45, 16384
    s_nop 0
    buffer_load_dwordx4 v8, s[20:23], s43 offen lds
    s_mov_b32 s43, 65536
    s_add_u32 m0, s46, 16384
    s_nop 0
    buffer_load_dwordx4 v10, s[24:27], s43 offen lds
    s_mov_b32 s43, 256
    s_add_u32 m0, s45, 32768
    s_nop 0
    buffer_load_dwordx4 v8, s[20:23], s43 offen lds
    s_mov_b32 s43, 131072
    s_add_u32 m0, s46, 32768
    s_nop 0
    buffer_load_dwordx4 v10, s[24:27], s43 offen lds
    s_and_b32 s43, s49, 1
    s_lshl_b32 s43, s43, 5
    s_lshl_b32 s44, s41, 6
    s_add_u32 s47, s43, s44
    s_lshl_b32 s43, s47, 2
    s_add_u32 s43, s43, 14680064
    v_and_b32 v2, 31, v1
    v_lshlrev_b32 v2, 2, v2
    buffer_load_dword v15, v2, s[20:23], s43 offen
    s_and_b32 s43, s49, 1
    s_lshl_b32 s43, s43, 5
    v_and_b32 v2, 31, v1
    v_add_u32 v2, s43, v2
    v_lshrrev_b32 v3, 1, v2
    v_and_b32 v3, 7, v3
    v_lshrrev_b32 v4, 5, v1
    v_lshlrev_b32 v2, 7, v2
    s_lshl_b32 s43, s48, 2
    v_add_u32 v4, s43, v4
    v_add_u32 v5, 0, v4
    v_xor_b32 v5, v5, v3
    v_lshl_add_u32 v12, v5, 4, v2
    v_add_u32 v5, 2, v4
    v_xor_b32 v5, v5, v3
    v_lshl_add_u32 v13, v5, 4, v2
    v_lshrrev_b32 v2, 5, v1
    v_lshlrev_b32 v2, 2, v2
    v_bfe_u32 v3, v1, 2, 2
    v_add_u32 v2, v2, v3
    s_lshl_b32 s43, s48, 5
    v_add_u32 v2, s43, v2
    v_lshlrev_b32 v2, 7, v2
    v_and_b32 v4, 1, v1
    v_lshl_add_u32 v2, v4, 3, v2
    v_add_u32 v2, 8192, v2
    v_bfe_u32 v4, v1, 4, 1
    v_lshlrev_b32 v4, 1, v4
    v_bfe_u32 v5, v1, 1, 1
    v_add_u32 v4, v4, v5
    s_lshr_b32 s43, s49, 1
    s_lshl_b32 s43, s43, 2
    v_add_u32 v4, s43, v4
    v_lshlrev_b32 v3, 1, v3
    v_and_b32 v3, 4, v3
    v_xor_b32 v4, v4, v3
    v_lshl_add_u32 v14, v4, 4, v2
    v_mov_b32 v48, 0
    v_mov_b32 v49, 0
    v_mov_b32 v50, 0
    v_mov_b32 v51, 0
    v_mov_b32 v52, 0
    v_mov_b32 v53, 0
    v_mov_b32 v54, 0
    v_mov_b32 v55, 0
    v_mov_b32 v56, 0
    v_mov_b32 v57, 0
    v_mov_b32 v58, 0
    v_mov_b32 v59, 0
    v_mov_b32 v60, 0
    v_mov_b32 v61, 0
    v_mov_b32 v62, 0
    v_mov_b32 v63, 0
    v_mov_b32 v64, 0
    v_mov_b32 v65, 0
    v_mov_b32 v66, 0
    v_mov_b32 v67, 0
    v_mov_b32 v68, 0
    v_mov_b32 v69, 0
    v_mov_b32 v70, 0
    v_mov_b32 v71, 0
    v_mov_b32 v72, 0
    v_mov_b32 v73, 0
    v_mov_b32 v74, 0
    v_mov_b32 v75, 0
    v_mov_b32 v76, 0
    v_mov_b32 v77, 0
    v_mov_b32 v78, 0
    v_mov_b32 v79, 0
    s_waitcnt vmcnt(5)
    s_barrier
    ds_read_b128 v[24:27], v12
    ds_read_b64_tr_b16 v[32:33], v14 offset:0
    ds_read_b64_tr_b16 v[34:35], v14 offset:1024
    ds_read_b128 v[28:31], v13
    ds_read_b64_tr_b16 v[36:37], v14 offset:2048
    ds_read_b64_tr_b16 v[38:39], v14 offset:3072
    s_waitcnt lgkmcnt(3)
    v_mfma_f32_32x32x16_bf16 v[48:63], v[32:35], v[24:27], v[48:63]
    s_waitcnt vmcnt(3)
    s_barrier
    s_mov_b32 s43, 384
    s_add_u32 m0, s45, 49152
    s_nop 0
    buffer_load_dwordx4 v8, s[20:23], s43 offen lds
    s_mov_b32 s43, 196608
    s_add_u32 m0, s46, 49152
    s_nop 0
    buffer_load_dwordx4 v10, s[24:27], s43 offen lds
    s_mov_b32 s43, 512
    s_add_u32 m0, s45, 65536
    s_nop 0
    buffer_load_dwordx4 v8, s[20:23], s43 offen lds
    s_mov_b32 s43, 262144
    s_add_u32 m0, s46, 65536
    s_nop 0
    buffer_load_dwordx4 v10, s[24:27], s43 offen lds
    v_add_u32 v12, 16384, v12
    v_add_u32 v13, 16384, v13
    v_add_u32 v14, 16384, v14
    ds_read_b128 v[24:27], v12
    ds_read_b64_tr_b16 v[32:33], v14 offset:0
    ds_read_b64_tr_b16 v[34:35], v14 offset:1024
    s_waitcnt lgkmcnt(3)
    v_mfma_f32_32x32x16_bf16 v[48:63], v[36:39], v[28:31], v[48:63]
    ds_read_b128 v[28:31], v13
    ds_read_b64_tr_b16 v[36:37], v14 offset:2048
    ds_read_b64_tr_b16 v[38:39], v14 offset:3072
    s_waitcnt lgkmcnt(3)
    v_mfma_f32_32x32x16_bf16 v[48:63], v[32:35], v[24:27], v[48:63]
    s_waitcnt vmcnt(5)
    s_barrier
    s_mov_b32 s43, 640
    s_add_u32 m0, s45, 81920
    s_nop 0
    buffer_load_dwordx4 v8, s[20:23], s43 offen lds
    s_mov_b32 s43, 327680
    s_add_u32 m0, s46, 81920
    s_nop 0
    buffer_load_dwordx4 v10, s[24:27], s43 offen lds
    s_mov_b32 s43, 768
    s_add_u32 m0, s45, 98304
    s_nop 0
    buffer_load_dwordx4 v8, s[20:23], s43 offen lds
    s_mov_b32 s43, 393216
    s_add_u32 m0, s46, 98304
    s_nop 0
    buffer_load_dwordx4 v10, s[24:27], s43 offen lds
    v_add_u32 v12, 16384, v12
    v_add_u32 v13, 16384, v13
    v_add_u32 v14, 16384, v14
    ds_read_b128 v[24:27], v12
    ds_read_b64_tr_b16 v[32:33], v14 offset:0
    ds_read_b64_tr_b16 v[34:35], v14 offset:1024
    s_waitcnt lgkmcnt(3)
    v_mfma_f32_32x32x16_bf16 v[48:63], v[36:39], v[28:31], v[48:63]
    ds_read_b128 v[28:31], v13
    ds_read_b64_tr_b16 v[36:37], v14 offset:2048
    ds_read_b64_tr_b16 v[38:39], v14 offset:3072
    s_waitcnt lgkmcnt(3)
    v_mfma_f32_32x32x16_bf16 v[48:63], v[32:35], v[24:27], v[48:63]
    s_waitcnt vmcnt(6)
    s_barrier
    s_mov_b32 s43, 896
    s_add_u32 m0, s45, 114688
    s_nop 0
    buffer_load_dwordx4 v8, s[20:23], s43 offen lds
    s_mov_b32 s43, 458752
    s_add_u32 m0, s46, 114688
    s_nop 0
    buffer_load_dwordx4 v10, s[24:27], s43 offen lds
    s_mov_b32 s43, 0
    s_add_u32 m0, s45, 131072
    s_nop 0
    buffer_load_dwordx4 v9, s[20:23], s43 offen lds
    s_mov_b32 s43, 0
    s_add_u32 m0, s46, 131072
    s_nop 0
    buffer_load_dwordx4 v10, s[28:31], s43 offen lds
    v_add_u32 v12, 16384, v12
    v_add_u32 v13, 16384, v13
    v_add_u32 v14, 16384, v14
    ds_read_b128 v[24:27], v12
    ds_read_b64_tr_b16 v[32:33], v14 offset:0
    ds_read_b64_tr_b16 v[34:35], v14 offset:1024
    s_waitcnt lgkmcnt(3)
    v_mfma_f32_32x32x16_bf16 v[48:63], v[36:39], v[28:31], v[48:63]
    ds_read_b128 v[28:31], v13
    ds_read_b64_tr_b16 v[36:37], v14 offset:2048
    ds_read_b64_tr_b16 v[38:39], v14 offset:3072
    s_waitcnt lgkmcnt(3)
    v_mfma_f32_32x32x16_bf16 v[48:63], v[32:35], v[24:27], v[48:63]
    s_waitcnt vmcnt(8)
    s_barrier
    s_mov_b32 s43, 128
    s_add_u32 m0, s45, 0
    s_nop 0
    buffer_load_dwordx4 v9, s[20:23], s43 offen lds
    s_mov_b32 s43, 65536
    s_add_u32 m0, s46, 0
    s_nop 0
    buffer_load_dwordx4 v10, s[28:31], s43 offen lds
    s_mov_b32 s43, 256
    s_add_u32 m0, s45, 16384
    s_nop 0
    buffer_load_dwordx4 v9, s[20:23], s43 offen lds
    s_mov_b32 s43, 131072
    s_add_u32 m0, s46, 16384
    s_nop 0
    buffer_load_dwordx4 v10, s[28:31], s43 offen lds
    v_add_u32 v12, 16384, v12
    v_add_u32 v13, 16384, v13
    v_add_u32 v14, 16384, v14
    ds_read_b128 v[24:27], v12
    ds_read_b64_tr_b16 v[32:33], v14 offset:0
    ds_read_b64_tr_b16 v[34:35], v14 offset:1024
    s_waitcnt lgkmcnt(3)
    v_mfma_f32_32x32x16_bf16 v[48:63], v[36:39], v[28:31], v[48:63]
    ds_read_b128 v[28:31], v13
    ds_read_b64_tr_b16 v[36:37], v14 offset:2048
    ds_read_b64_tr_b16 v[38:39], v14 offset:3072
    s_waitcnt lgkmcnt(3)
    v_mfma_f32_32x32x16_bf16 v[48:63], v[32:35], v[24:27], v[48:63]
    s_waitcnt vmcnt(10)
    s_barrier
    s_mov_b32 s43, 384
    s_add_u32 m0, s45, 32768
    s_nop 0
    buffer_load_dwordx4 v9, s[20:23], s43 offen lds
    s_mov_b32 s43, 196608
    s_add_u32 m0, s46, 32768
    s_nop 0
    buffer_load_dwordx4 v10, s[28:31], s43 offen lds
    s_mov_b32 s43, 512
    s_add_u32 m0, s45, 49152
    s_nop 0
    buffer_load_dwordx4 v9, s[20:23], s43 offen lds
    s_mov_b32 s43, 262144
    s_add_u32 m0, s46, 49152
    s_nop 0
    buffer_load_dwordx4 v10, s[28:31], s43 offen lds
    v_add_u32 v12, 16384, v12
    v_add_u32 v13, 16384, v13
    v_add_u32 v14, 16384, v14
    ds_read_b128 v[24:27], v12
    ds_read_b64_tr_b16 v[32:33], v14 offset:0
    ds_read_b64_tr_b16 v[34:35], v14 offset:1024
    s_waitcnt lgkmcnt(3)
    v_mfma_f32_32x32x16_bf16 v[48:63], v[36:39], v[28:31], v[48:63]
    ds_read_b128 v[28:31], v13
    ds_read_b64_tr_b16 v[36:37], v14 offset:2048
    ds_read_b64_tr_b16 v[38:39], v14 offset:3072
    s_waitcnt lgkmcnt(3)
    v_mfma_f32_32x32x16_bf16 v[48:63], v[32:35], v[24:27], v[48:63]
    s_waitcnt vmcnt(12)
    s_barrier
    s_mov_b32 s43, 640
    s_add_u32 m0, s45, 65536
    s_nop 0
    buffer_load_dwordx4 v9, s[20:23], s43 offen lds
    s_mov_b32 s43, 327680
    s_add_u32 m0, s46, 65536
    s_nop 0
    buffer_load_dwordx4 v10, s[28:31], s43 offen lds
    v_add_u32 v12, 16384, v12
    v_add_u32 v13, 16384, v13
    v_add_u32 v14, 16384, v14
    ds_read_b128 v[24:27], v12
    ds_read_b64_tr_b16 v[32:33], v14 offset:0
    ds_read_b64_tr_b16 v[34:35], v14 offset:1024
    s_waitcnt lgkmcnt(3)
    v_mfma_f32_32x32x16_bf16 v[48:63], v[36:39], v[28:31], v[48:63]
    ds_read_b128 v[28:31], v13
    ds_read_b64_tr_b16 v[36:37], v14 offset:2048
    ds_read_b64_tr_b16 v[38:39], v14 offset:3072
    s_waitcnt lgkmcnt(3)
    v_mfma_f32_32x32x16_bf16 v[48:63], v[32:35], v[24:27], v[48:63]
    s_waitcnt vmcnt(12)
    s_barrier
    s_mov_b32 s43, 768
    s_add_u32 m0, s45, 81920
    s_nop 0
    buffer_load_dwordx4 v9, s[20:23], s43 offen lds
    s_mov_b32 s43, 393216
    s_add_u32 m0, s46, 81920
    s_nop 0
    buffer_load_dwordx4 v10, s[28:31], s43 offen lds
    v_add_u32 v12, 16384, v12
    v_add_u32 v13, 16384, v13
    v_add_u32 v14, 16384, v14
    ds_read_b128 v[24:27], v12
    ds_read_b64_tr_b16 v[32:33], v14 offset:0
    ds_read_b64_tr_b16 v[34:35], v14 offset:1024
    s_waitcnt lgkmcnt(3)
    v_mfma_f32_32x32x16_bf16 v[48:63], v[36:39], v[28:31], v[48:63]
    ds_read_b128 v[28:31], v13
    ds_read_b64_tr_b16 v[36:37], v14 offset:2048
    ds_read_b64_tr_b16 v[38:39], v14 offset:3072
    s_waitcnt lgkmcnt(3)
    v_mfma_f32_32x32x16_bf16 v[48:63], v[32:35], v[24:27], v[48:63]
    s_waitcnt vmcnt(12)
    s_barrier
    s_mov_b32 s43, 896
    s_add_u32 m0, s45, 98304
    s_nop 0
    buffer_load_dwordx4 v9, s[20:23], s43 offen lds
    s_mov_b32 s43, 458752
    s_add_u32 m0, s46, 98304
    s_nop 0
    buffer_load_dwordx4 v10, s[28:31], s43 offen lds
    v_add_u32 v12, 16384, v12
    v_add_u32 v13, 16384, v13
    v_add_u32 v14, 16384, v14
    ds_read_b128 v[24:27], v12
    ds_read_b64_tr_b16 v[32:33], v14 offset:0
    ds_read_b64_tr_b16 v[34:35], v14 offset:1024
    s_waitcnt lgkmcnt(3)
    v_mfma_f32_32x32x16_bf16 v[48:63], v[36:39], v[28:31], v[48:63]
    ds_read_b128 v[28:31], v13
    ds_read_b64_tr_b16 v[36:37], v14 offset:2048
    ds_read_b64_tr_b16 v[38:39], v14 offset:3072
    s_waitcnt lgkmcnt(3)
    v_mfma_f32_32x32x16_bf16 v[64:79], v[32:35], v[24:27], v[64:79]
    s_waitcnt vmcnt(12)
    s_barrier
    s_mov_b32 s43, 1024
    s_add_u32 m0, s45, 114688
    s_nop 0
    buffer_load_dwordx4 v9, s[20:23], s43 offen lds
    s_mov_b32 s43, 524288
    s_add_u32 m0, s46, 114688
    s_nop 0
    buffer_load_dwordx4 v10, s[28:31], s43 offen lds
    v_subrev_u32 v12, 131072, v12
    v_subrev_u32 v13, 131072, v13
    v_subrev_u32 v14, 131072, v14
    ds_read_b128 v[24:27], v12
    ds_read_b64_tr_b16 v[32:33], v14 offset:0
    ds_read_b64_tr_b16 v[34:35], v14 offset:1024
    s_waitcnt lgkmcnt(3)
    v_mfma_f32_32x32x16_bf16 v[64:79], v[36:39], v[28:31], v[64:79]
    ds_read_b128 v[28:31], v13
    ds_read_b64_tr_b16 v[36:37], v14 offset:2048
    ds_read_b64_tr_b16 v[38:39], v14 offset:3072
    s_waitcnt lgkmcnt(3)
    v_mfma_f32_32x32x16_bf16 v[64:79], v[32:35], v[24:27], v[64:79]
    s_waitcnt vmcnt(12)
    s_barrier
    s_mov_b32 s43, 1152
    s_add_u32 m0, s45, 131072
    s_nop 0
    buffer_load_dwordx4 v9, s[20:23], s43 offen lds
    s_mov_b32 s43, 589824
    s_add_u32 m0, s46, 131072
    s_nop 0
    buffer_load_dwordx4 v10, s[28:31], s43 offen lds
    v_add_u32 v12, 16384, v12
    v_add_u32 v13, 16384, v13
    v_add_u32 v14, 16384, v14
    ds_read_b128 v[24:27], v12
    ds_read_b64_tr_b16 v[32:33], v14 offset:0
    ds_read_b64_tr_b16 v[34:35], v14 offset:1024
    s_waitcnt lgkmcnt(3)
    v_mfma_f32_32x32x16_bf16 v[64:79], v[36:39], v[28:31], v[64:79]
    ds_read_b128 v[28:31], v13
    ds_read_b64_tr_b16 v[36:37], v14 offset:2048
    ds_read_b64_tr_b16 v[38:39], v14 offset:3072
    s_waitcnt lgkmcnt(3)
    v_mfma_f32_32x32x16_bf16 v[64:79], v[32:35], v[24:27], v[64:79]
    s_waitcnt vmcnt(12)
    s_barrier
    s_mov_b32 s43, 1280
    s_add_u32 m0, s45, 0
    s_nop 0
    buffer_load_dwordx4 v9, s[20:23], s43 offen lds
    s_mov_b32 s43, 655360
    s_add_u32 m0, s46, 0
    s_nop 0
    buffer_load_dwordx4 v10, s[28:31], s43 offen lds
    v_add_u32 v12, 16384, v12
    v_add_u32 v13, 16384, v13
    v_add_u32 v14, 16384, v14
    ds_read_b128 v[24:27], v12
    ds_read_b64_tr_b16 v[32:33], v14 offset:0
    ds_read_b64_tr_b16 v[34:35], v14 offset:1024
    s_waitcnt lgkmcnt(3)
    v_mfma_f32_32x32x16_bf16 v[64:79], v[36:39], v[28:31], v[64:79]
    ds_read_b128 v[28:31], v13
    ds_read_b64_tr_b16 v[36:37], v14 offset:2048
    ds_read_b64_tr_b16 v[38:39], v14 offset:3072
    s_waitcnt lgkmcnt(3)
    v_mfma_f32_32x32x16_bf16 v[64:79], v[32:35], v[24:27], v[64:79]
    s_waitcnt vmcnt(12)
    s_barrier
    s_mov_b32 s43, 1408
    s_add_u32 m0, s45, 16384
    s_nop 0
    buffer_load_dwordx4 v9, s[20:23], s43 offen lds
    s_mov_b32 s43, 720896
    s_add_u32 m0, s46, 16384
    s_nop 0
    buffer_load_dwordx4 v10, s[28:31], s43 offen lds
    v_add_u32 v12, 16384, v12
    v_add_u32 v13, 16384, v13
    v_add_u32 v14, 16384, v14
    ds_read_b128 v[24:27], v12
    ds_read_b64_tr_b16 v[32:33], v14 offset:0
    ds_read_b64_tr_b16 v[34:35], v14 offset:1024
    s_waitcnt lgkmcnt(3)
    v_mfma_f32_32x32x16_bf16 v[64:79], v[36:39], v[28:31], v[64:79]
    ds_read_b128 v[28:31], v13
    ds_read_b64_tr_b16 v[36:37], v14 offset:2048
    ds_read_b64_tr_b16 v[38:39], v14 offset:3072
    s_waitcnt lgkmcnt(3)
    v_mfma_f32_32x32x16_bf16 v[64:79], v[32:35], v[24:27], v[64:79]
    s_waitcnt vmcnt(12)
    s_barrier
    s_mov_b32 s43, 1536
    s_add_u32 m0, s45, 32768
    s_nop 0
    buffer_load_dwordx4 v9, s[20:23], s43 offen lds
    s_mov_b32 s43, 786432
    s_add_u32 m0, s46, 32768
    s_nop 0
    buffer_load_dwordx4 v10, s[28:31], s43 offen lds
    v_add_u32 v12, 16384, v12
    v_add_u32 v13, 16384, v13
    v_add_u32 v14, 16384, v14
    ds_read_b128 v[24:27], v12
    ds_read_b64_tr_b16 v[32:33], v14 offset:0
    ds_read_b64_tr_b16 v[34:35], v14 offset:1024
    s_waitcnt lgkmcnt(3)
    v_mfma_f32_32x32x16_bf16 v[64:79], v[36:39], v[28:31], v[64:79]
    ds_read_b128 v[28:31], v13
    ds_read_b64_tr_b16 v[36:37], v14 offset:2048
    ds_read_b64_tr_b16 v[38:39], v14 offset:3072
    s_waitcnt lgkmcnt(3)
    v_mfma_f32_32x32x16_bf16 v[64:79], v[32:35], v[24:27], v[64:79]
    s_waitcnt vmcnt(12)
    s_barrier
    s_mov_b32 s43, 1664
    s_add_u32 m0, s45, 49152
    s_nop 0
    buffer_load_dwordx4 v9, s[20:23], s43 offen lds
    s_mov_b32 s43, 851968
    s_add_u32 m0, s46, 49152
    s_nop 0
    buffer_load_dwordx4 v10, s[28:31], s43 offen lds
    v_add_u32 v12, 16384, v12
    v_add_u32 v13, 16384, v13
    v_add_u32 v14, 16384, v14
    ds_read_b128 v[24:27], v12
    ds_read_b64_tr_b16 v[32:33], v14 offset:0
    ds_read_b64_tr_b16 v[34:35], v14 offset:1024
    s_waitcnt lgkmcnt(3)
    v_mfma_f32_32x32x16_bf16 v[64:79], v[36:39], v[28:31], v[64:79]
    ds_read_b128 v[28:31], v13
    ds_read_b64_tr_b16 v[36:37], v14 offset:2048
    ds_read_b64_tr_b16 v[38:39], v14 offset:3072
    s_waitcnt lgkmcnt(3)
    v_mfma_f32_32x32x16_bf16 v[64:79], v[32:35], v[24:27], v[64:79]
    s_waitcnt vmcnt(12)
    s_barrier
    s_mov_b32 s43, 1792
    s_add_u32 m0, s45, 65536
    s_nop 0
    buffer_load_dwordx4 v9, s[20:23], s43 offen lds
    s_mov_b32 s43, 917504
    s_add_u32 m0, s46, 65536
    s_nop 0
    buffer_load_dwordx4 v10, s[28:31], s43 offen lds
    v_add_u32 v12, 16384, v12
    v_add_u32 v13, 16384, v13
    v_add_u32 v14, 16384, v14
    ds_read_b128 v[24:27], v12
    ds_read_b64_tr_b16 v[32:33], v14 offset:0
    ds_read_b64_tr_b16 v[34:35], v14 offset:1024
    s_waitcnt lgkmcnt(3)
    v_mfma_f32_32x32x16_bf16 v[64:79], v[36:39], v[28:31], v[64:79]
    ds_read_b128 v[28:31], v13
    ds_read_b64_tr_b16 v[36:37], v14 offset:2048
    ds_read_b64_tr_b16 v[38:39], v14 offset:3072
    s_waitcnt lgkmcnt(3)
    v_mfma_f32_32x32x16_bf16 v[64:79], v[32:35], v[24:27], v[64:79]
    s_waitcnt vmcnt(12)
    s_barrier
    s_mov_b32 s43, 1920
    s_add_u32 m0, s45, 81920
    s_nop 0
    buffer_load_dwordx4 v9, s[20:23], s43 offen lds
    s_mov_b32 s43, 983040
    s_add_u32 m0, s46, 81920
    s_nop 0
    buffer_load_dwordx4 v10, s[28:31], s43 offen lds
    v_add_u32 v12, 16384, v12
    v_add_u32 v13, 16384, v13
    v_add_u32 v14, 16384, v14
    ds_read_b128 v[24:27], v12
    ds_read_b64_tr_b16 v[32:33], v14 offset:0
    ds_read_b64_tr_b16 v[34:35], v14 offset:1024
    s_waitcnt lgkmcnt(3)
    v_mfma_f32_32x32x16_bf16 v[64:79], v[36:39], v[28:31], v[64:79]
    ds_read_b128 v[28:31], v13
    ds_read_b64_tr_b16 v[36:37], v14 offset:2048
    ds_read_b64_tr_b16 v[38:39], v14 offset:3072
    s_waitcnt lgkmcnt(3)
    v_mfma_f32_32x32x16_bf16 v[64:79], v[32:35], v[24:27], v[64:79]
    s_waitcnt vmcnt(12)
    s_barrier
    s_mov_b32 s43, 2048
    s_add_u32 m0, s45, 98304
    s_nop 0
    buffer_load_dwordx4 v9, s[20:23], s43 offen lds
    s_mov_b32 s43, 1048576
    s_add_u32 m0, s46, 98304
    s_nop 0
    buffer_load_dwordx4 v10, s[28:31], s43 offen lds
    v_add_u32 v12, 16384, v12
    v_add_u32 v13, 16384, v13
    v_add_u32 v14, 16384, v14
    ds_read_b128 v[24:27], v12
    ds_read_b64_tr_b16 v[32:33], v14 offset:0
    ds_read_b64_tr_b16 v[34:35], v14 offset:1024
    s_waitcnt lgkmcnt(3)
    v_mfma_f32_32x32x16_bf16 v[64:79], v[36:39], v[28:31], v[64:79]
    ds_read_b128 v[28:31], v13
    ds_read_b64_tr_b16 v[36:37], v14 offset:2048
    ds_read_b64_tr_b16 v[38:39], v14 offset:3072
    s_waitcnt lgkmcnt(3)
    v_mfma_f32_32x32x16_bf16 v[64:79], v[32:35], v[24:27], v[64:79]
    s_waitcnt vmcnt(12)
    s_barrier
    s_mov_b32 s43, 2176
    s_add_u32 m0, s45, 114688
    s_nop 0
    buffer_load_dwordx4 v9, s[20:23], s43 offen lds
    s_mov_b32 s43, 1114112
    s_add_u32 m0, s46, 114688
    s_nop 0
    buffer_load_dwordx4 v10, s[28:31], s43 offen lds
    v_subrev_u32 v12, 131072, v12
    v_subrev_u32 v13, 131072, v13
    v_subrev_u32 v14, 131072, v14
    ds_read_b128 v[24:27], v12
    ds_read_b64_tr_b16 v[32:33], v14 offset:0
    ds_read_b64_tr_b16 v[34:35], v14 offset:1024
    s_waitcnt lgkmcnt(3)
    v_mfma_f32_32x32x16_bf16 v[64:79], v[36:39], v[28:31], v[64:79]
    ds_read_b128 v[28:31], v13
    ds_read_b64_tr_b16 v[36:37], v14 offset:2048
    ds_read_b64_tr_b16 v[38:39], v14 offset:3072
    s_waitcnt lgkmcnt(3)
    v_mfma_f32_32x32x16_bf16 v[64:79], v[32:35], v[24:27], v[64:79]
    s_waitcnt vmcnt(12)
    s_barrier
    s_mov_b32 s43, 2304
    s_add_u32 m0, s45, 131072
    s_nop 0
    buffer_load_dwordx4 v9, s[20:23], s43 offen lds
    s_mov_b32 s43, 1179648
    s_add_u32 m0, s46, 131072
    s_nop 0
    buffer_load_dwordx4 v10, s[28:31], s43 offen lds
    v_add_u32 v12, 16384, v12
    v_add_u32 v13, 16384, v13
    v_add_u32 v14, 16384, v14
    ds_read_b128 v[24:27], v12
    ds_read_b64_tr_b16 v[32:33], v14 offset:0
    ds_read_b64_tr_b16 v[34:35], v14 offset:1024
    s_waitcnt lgkmcnt(3)
    v_mfma_f32_32x32x16_bf16 v[64:79], v[36:39], v[28:31], v[64:79]
    ds_read_b128 v[28:31], v13
    ds_read_b64_tr_b16 v[36:37], v14 offset:2048
    ds_read_b64_tr_b16 v[38:39], v14 offset:3072
    s_waitcnt lgkmcnt(3)
    v_mfma_f32_32x32x16_bf16 v[64:79], v[32:35], v[24:27], v[64:79]
    s_waitcnt vmcnt(12)
    s_barrier
    s_mov_b32 s43, 2432
    s_add_u32 m0, s45, 0
    s_nop 0
    buffer_load_dwordx4 v9, s[20:23], s43 offen lds
    s_mov_b32 s43, 1245184
    s_add_u32 m0, s46, 0
    s_nop 0
    buffer_load_dwordx4 v10, s[28:31], s43 offen lds
    v_add_u32 v12, 16384, v12
    v_add_u32 v13, 16384, v13
    v_add_u32 v14, 16384, v14
    ds_read_b128 v[24:27], v12
    ds_read_b64_tr_b16 v[32:33], v14 offset:0
    ds_read_b64_tr_b16 v[34:35], v14 offset:1024
    s_waitcnt lgkmcnt(3)
    v_mfma_f32_32x32x16_bf16 v[64:79], v[36:39], v[28:31], v[64:79]
    ds_read_b128 v[28:31], v13
    ds_read_b64_tr_b16 v[36:37], v14 offset:2048
    ds_read_b64_tr_b16 v[38:39], v14 offset:3072
    s_waitcnt lgkmcnt(3)
    v_mfma_f32_32x32x16_bf16 v[64:79], v[32:35], v[24:27], v[64:79]
    s_waitcnt vmcnt(12)
    s_barrier
    s_mov_b32 s43, 2560
    s_add_u32 m0, s45, 16384
    s_nop 0
    buffer_load_dwordx4 v9, s[20:23], s43 offen lds
    s_mov_b32 s43, 1310720
    s_add_u32 m0, s46, 16384
    s_nop 0
    buffer_load_dwordx4 v10, s[28:31], s43 offen lds
    v_add_u32 v12, 16384, v12
    v_add_u32 v13, 16384, v13
    v_add_u32 v14, 16384, v14
    ds_read_b128 v[24:27], v12
    ds_read_b64_tr_b16 v[32:33], v14 offset:0
    ds_read_b64_tr_b16 v[34:35], v14 offset:1024
    s_waitcnt lgkmcnt(3)
    v_mfma_f32_32x32x16_bf16 v[64:79], v[36:39], v[28:31], v[64:79]
    ds_read_b128 v[28:31], v13
    ds_read_b64_tr_b16 v[36:37], v14 offset:2048
    ds_read_b64_tr_b16 v[38:39], v14 offset:3072
    s_waitcnt lgkmcnt(3)
    v_mfma_f32_32x32x16_bf16 v[64:79], v[32:35], v[24:27], v[64:79]
    s_waitcnt vmcnt(12)
    s_barrier
    s_mov_b32 s43, 2688
    s_add_u32 m0, s45, 32768
    s_nop 0
    buffer_load_dwordx4 v9, s[20:23], s43 offen lds
    s_mov_b32 s43, 1376256
    s_add_u32 m0, s46, 32768
    s_nop 0
    buffer_load_dwordx4 v10, s[28:31], s43 offen lds
    v_add_u32 v12, 16384, v12
    v_add_u32 v13, 16384, v13
    v_add_u32 v14, 16384, v14
    ds_read_b128 v[24:27], v12
    ds_read_b64_tr_b16 v[32:33], v14 offset:0
    ds_read_b64_tr_b16 v[34:35], v14 offset:1024
    s_waitcnt lgkmcnt(3)
    v_mfma_f32_32x32x16_bf16 v[64:79], v[36:39], v[28:31], v[64:79]
    ds_read_b128 v[28:31], v13
    ds_read_b64_tr_b16 v[36:37], v14 offset:2048
    ds_read_b64_tr_b16 v[38:39], v14 offset:3072
    s_waitcnt lgkmcnt(3)
    v_mfma_f32_32x32x16_bf16 v[64:79], v[32:35], v[24:27], v[64:79]
    s_waitcnt vmcnt(12)
    s_barrier
    v_add_u32 v12, 16384, v12
    v_add_u32 v13, 16384, v13
    v_add_u32 v14, 16384, v14
    ds_read_b128 v[24:27], v12
    ds_read_b64_tr_b16 v[32:33], v14 offset:0
    ds_read_b64_tr_b16 v[34:35], v14 offset:1024
    s_waitcnt lgkmcnt(3)
    v_mfma_f32_32x32x16_bf16 v[64:79], v[36:39], v[28:31], v[64:79]
    ds_read_b128 v[28:31], v13
    ds_read_b64_tr_b16 v[36:37], v14 offset:2048
    ds_read_b64_tr_b16 v[38:39], v14 offset:3072
    s_waitcnt lgkmcnt(3)
    v_mfma_f32_32x32x16_bf16 v[64:79], v[32:35], v[24:27], v[64:79]
    s_waitcnt vmcnt(10)
    s_barrier
    v_add_u32 v12, 16384, v12
    v_add_u32 v13, 16384, v13
    v_add_u32 v14, 16384, v14
    ds_read_b128 v[24:27], v12
    ds_read_b64_tr_b16 v[32:33], v14 offset:0
    ds_read_b64_tr_b16 v[34:35], v14 offset:1024
    s_waitcnt lgkmcnt(3)
    v_mfma_f32_32x32x16_bf16 v[64:79], v[36:39], v[28:31], v[64:79]
    ds_read_b128 v[28:31], v13
    ds_read_b64_tr_b16 v[36:37], v14 offset:2048
    ds_read_b64_tr_b16 v[38:39], v14 offset:3072
    s_waitcnt lgkmcnt(3)
    v_mfma_f32_32x32x16_bf16 v[64:79], v[32:35], v[24:27], v[64:79]
    s_waitcnt vmcnt(8)
    s_barrier
    v_add_u32 v12, 16384, v12
    v_add_u32 v13, 16384, v13
    v_add_u32 v14, 16384, v14
    ds_read_b128 v[24:27], v12
    ds_read_b64_tr_b16 v[32:33], v14 offset:0
    ds_read_b64_tr_b16 v[34:35], v14 offset:1024
    s_waitcnt lgkmcnt(3)
    v_mfma_f32_32x32x16_bf16 v[64:79], v[36:39], v[28:31], v[64:79]
    ds_read_b128 v[28:31], v13
    ds_read_b64_tr_b16 v[36:37], v14 offset:2048
    ds_read_b64_tr_b16 v[38:39], v14 offset:3072
    s_waitcnt lgkmcnt(3)
    v_mfma_f32_32x32x16_bf16 v[64:79], v[32:35], v[24:27], v[64:79]
    s_waitcnt vmcnt(6)
    s_barrier
    v_add_u32 v12, 16384, v12
    v_add_u32 v13, 16384, v13
    v_add_u32 v14, 16384, v14
    ds_read_b128 v[24:27], v12
    ds_read_b64_tr_b16 v[32:33], v14 offset:0
    ds_read_b64_tr_b16 v[34:35], v14 offset:1024
    s_waitcnt lgkmcnt(3)
    v_mfma_f32_32x32x16_bf16 v[64:79], v[36:39], v[28:31], v[64:79]
    ds_read_b128 v[28:31], v13
    ds_read_b64_tr_b16 v[36:37], v14 offset:2048
    ds_read_b64_tr_b16 v[38:39], v14 offset:3072
    s_waitcnt lgkmcnt(3)
    v_mfma_f32_32x32x16_bf16 v[64:79], v[32:35], v[24:27], v[64:79]
    s_waitcnt vmcnt(4)
    s_barrier
    v_subrev_u32 v12, 131072, v12
    v_subrev_u32 v13, 131072, v13
    v_subrev_u32 v14, 131072, v14
    ds_read_b128 v[24:27], v12
    ds_read_b64_tr_b16 v[32:33], v14 offset:0
    ds_read_b64_tr_b16 v[34:35], v14 offset:1024
    s_waitcnt lgkmcnt(3)
    v_mfma_f32_32x32x16_bf16 v[64:79], v[36:39], v[28:31], v[64:79]
    ds_read_b128 v[28:31], v13
    ds_read_b64_tr_b16 v[36:37], v14 offset:2048
    ds_read_b64_tr_b16 v[38:39], v14 offset:3072
    s_waitcnt lgkmcnt(3)
    v_mfma_f32_32x32x16_bf16 v[64:79], v[32:35], v[24:27], v[64:79]
    s_waitcnt vmcnt(2)
    s_barrier
    v_add_u32 v12, 16384, v12
    v_add_u32 v13, 16384, v13
    v_add_u32 v14, 16384, v14
    ds_read_b128 v[24:27], v12
    ds_read_b64_tr_b16 v[32:33], v14 offset:0
    ds_read_b64_tr_b16 v[34:35], v14 offset:1024
    s_waitcnt lgkmcnt(3)
    v_mfma_f32_32x32x16_bf16 v[64:79], v[36:39], v[28:31], v[64:79]
    ds_read_b128 v[28:31], v13
    ds_read_b64_tr_b16 v[36:37], v14 offset:2048
    ds_read_b64_tr_b16 v[38:39], v14 offset:3072
    s_waitcnt lgkmcnt(3)
    v_mfma_f32_32x32x16_bf16 v[64:79], v[32:35], v[24:27], v[64:79]
    s_waitcnt vmcnt(0)
    s_barrier
    v_add_u32 v12, 16384, v12
    v_add_u32 v13, 16384, v13
    v_add_u32 v14, 16384, v14
    ds_read_b128 v[24:27], v12
    ds_read_b64_tr_b16 v[32:33], v14 offset:0
    ds_read_b64_tr_b16 v[34:35], v14 offset:1024
    s_waitcnt lgkmcnt(3)
    v_mfma_f32_32x32x16_bf16 v[64:79], v[36:39], v[28:31], v[64:79]
    s_cmp_lg_u32 s48, 0
    s_cbranch_scc1 K3_SKIPLAST
    ds_read_b128 v[28:31], v13
    ds_read_b64_tr_b16 v[36:37], v14 offset:2048
    ds_read_b64_tr_b16 v[38:39], v14 offset:3072
    s_waitcnt lgkmcnt(3)
    v_mfma_f32_32x32x16_bf16 v[64:79], v[32:35], v[24:27], v[64:79]
    s_waitcnt lgkmcnt(0)
    v_mfma_f32_32x32x16_bf16 v[64:79], v[36:39], v[28:31], v[64:79]
K3_SKIPLAST:
    s_waitcnt lgkmcnt(0)
    s_nop 15
    s_barrier
    v_lshlrev_b32 v2, 4, v1
    s_lshl_b32 s43, s49, 13
    v_add_u32 v2, s43, v2
    s_cmp_eq_u32 s48, 0
    s_cbranch_scc1 K3_RD
    ds_write_b128 v2, v[48:51] offset:0
    ds_write_b128 v2, v[52:55] offset:1024
    ds_write_b128 v2, v[56:59] offset:2048
    ds_write_b128 v2, v[60:63] offset:3072
    ds_write_b128 v2, v[64:67] offset:4096
    ds_write_b128 v2, v[68:71] offset:5120
    ds_write_b128 v2, v[72:75] offset:6144
    ds_write_b128 v2, v[76:79] offset:7168
    s_waitcnt lgkmcnt(0)
    s_barrier
    s_branch K3_END
K3_RD:
    s_barrier
    ds_read_b128 v[96:99], v2 offset:0
    ds_read_b128 v[100:103], v2 offset:1024
    ds_read_b128 v[104:107], v2 offset:2048
    ds_read_b128 v[108:111], v2 offset:3072
    ds_read_b128 v[112:115], v2 offset:4096
    ds_read_b128 v[116:119], v2 offset:5120
    ds_read_b128 v[120:123], v2 offset:6144
    ds_read_b128 v[124:127], v2 offset:7168
    s_waitcnt lgkmcnt(0)
    v_pk_add_f32 v[48:49], v[48:49], v[96:97]
    v_pk_add_f32 v[50:51], v[50:51], v[98:99]
    v_pk_add_f32 v[52:53], v[52:53], v[100:101]
    v_pk_add_f32 v[54:55], v[54:55], v[102:103]
    v_pk_add_f32 v[56:57], v[56:57], v[104:105]
    v_pk_add_f32 v[58:59], v[58:59], v[106:107]
    v_pk_add_f32 v[60:61], v[60:61], v[108:109]
    v_pk_add_f32 v[62:63], v[62:63], v[110:111]
    v_pk_add_f32 v[64:65], v[64:65], v[112:113]
    v_pk_add_f32 v[66:67], v[66:67], v[114:115]
    v_pk_add_f32 v[68:69], v[68:69], v[116:117]
    v_pk_add_f32 v[70:71], v[70:71], v[118:119]
    v_pk_add_f32 v[72:73], v[72:73], v[120:121]
    v_pk_add_f32 v[74:75], v[74:75], v[122:123]
    v_pk_add_f32 v[76:77], v[76:77], v[124:125]
    v_pk_add_f32 v[78:79], v[78:79], v[126:127]
    v_sub_f32 v80, 1.0, v15
    v_cvt_pk_bf16_f32 v80, v80, v80
    v_lshlrev_b32 v80, 16, v80
    v_cvt_pk_bf16_f32 v81, v48, v49
    v_lshlrev_b32 v48, 16, v81
    v_and_b32 v49, 0xffff0000, v81
    v_cvt_pk_bf16_f32 v81, v64, v65
    v_lshlrev_b32 v64, 16, v81
    v_and_b32 v65, 0xffff0000, v81
    v_mul_f32 v48, v15, v48
    v_mul_f32 v49, v15, v49
    v_mul_f32 v64, v80, v64
    v_mul_f32 v65, v80, v65
    v_cvt_pk_bf16_f32 v81, v48, v49
    v_lshlrev_b32 v48, 16, v81
    v_and_b32 v49, 0xffff0000, v81
    v_cvt_pk_bf16_f32 v81, v64, v65
    v_lshlrev_b32 v64, 16, v81
    v_and_b32 v65, 0xffff0000, v81
    v_add_f32 v48, v48, v64
    v_add_f32 v49, v49, v65
    v_cvt_pk_bf16_f32 v84, v48, v49
    v_cvt_pk_bf16_f32 v81, v50, v51
    v_lshlrev_b32 v50, 16, v81
    v_and_b32 v51, 0xffff0000, v81
    v_cvt_pk_bf16_f32 v81, v66, v67
    v_lshlrev_b32 v66, 16, v81
    v_and_b32 v67, 0xffff0000, v81
    v_mul_f32 v50, v15, v50
    v_mul_f32 v51, v15, v51
    v_mul_f32 v66, v80, v66
    v_mul_f32 v67, v80, v67
    v_cvt_pk_bf16_f32 v81, v50, v51
    v_lshlrev_b32 v50, 16, v81
    v_and_b32 v51, 0xffff0000, v81
    v_cvt_pk_bf16_f32 v81, v66, v67
    v_lshlrev_b32 v66, 16, v81
    v_and_b32 v67, 0xffff0000, v81
    v_add_f32 v50, v50, v66
    v_add_f32 v51, v51, v67
    v_cvt_pk_bf16_f32 v85, v50, v51
    v_cvt_pk_bf16_f32 v81, v52, v53
    v_lshlrev_b32 v52, 16, v81
    v_and_b32 v53, 0xffff0000, v81
    v_cvt_pk_bf16_f32 v81, v68, v69
    v_lshlrev_b32 v68, 16, v81
    v_and_b32 v69, 0xffff0000, v81
    v_mul_f32 v52, v15, v52
    v_mul_f32 v53, v15, v53
    v_mul_f32 v68, v80, v68
    v_mul_f32 v69, v80, v69
    v_cvt_pk_bf16_f32 v81, v52, v53
    v_lshlrev_b32 v52, 16, v81
    v_and_b32 v53, 0xffff0000, v81
    v_cvt_pk_bf16_f32 v81, v68, v69
    v_lshlrev_b32 v68, 16, v81
    v_and_b32 v69, 0xffff0000, v81
    v_add_f32 v52, v52, v68
    v_add_f32 v53, v53, v69
    v_cvt_pk_bf16_f32 v86, v52, v53
    v_cvt_pk_bf16_f32 v81, v54, v55
    v_lshlrev_b32 v54, 16, v81
    v_and_b32 v55, 0xffff0000, v81
    v_cvt_pk_bf16_f32 v81, v70, v71
    v_lshlrev_b32 v70, 16, v81
    v_and_b32 v71, 0xffff0000, v81
    v_mul_f32 v54, v15, v54
    v_mul_f32 v55, v15, v55
    v_mul_f32 v70, v80, v70
    v_mul_f32 v71, v80, v71
    v_cvt_pk_bf16_f32 v81, v54, v55
    v_lshlrev_b32 v54, 16, v81
    v_and_b32 v55, 0xffff0000, v81
    v_cvt_pk_bf16_f32 v81, v70, v71
    v_lshlrev_b32 v70, 16, v81
    v_and_b32 v71, 0xffff0000, v81
    v_add_f32 v54, v54, v70
    v_add_f32 v55, v55, v71
    v_cvt_pk_bf16_f32 v87, v54, v55
    v_cvt_pk_bf16_f32 v81, v56, v57
    v_lshlrev_b32 v56, 16, v81
    v_and_b32 v57, 0xffff0000, v81
    v_cvt_pk_bf16_f32 v81, v72, v73
    v_lshlrev_b32 v72, 16, v81
    v_and_b32 v73, 0xffff0000, v81
    v_mul_f32 v56, v15, v56
    v_mul_f32 v57, v15, v57
    v_mul_f32 v72, v80, v72
    v_mul_f32 v73, v80, v73
    v_cvt_pk_bf16_f32 v81, v56, v57
    v_lshlrev_b32 v56, 16, v81
    v_and_b32 v57, 0xffff0000, v81
    v_cvt_pk_bf16_f32 v81, v72, v73
    v_lshlrev_b32 v72, 16, v81
    v_and_b32 v73, 0xffff0000, v81
    v_add_f32 v56, v56, v72
    v_add_f32 v57, v57, v73
    v_cvt_pk_bf16_f32 v88, v56, v57
    v_cvt_pk_bf16_f32 v81, v58, v59
    v_lshlrev_b32 v58, 16, v81
    v_and_b32 v59, 0xffff0000, v81
    v_cvt_pk_bf16_f32 v81, v74, v75
    v_lshlrev_b32 v74, 16, v81
    v_and_b32 v75, 0xffff0000, v81
    v_mul_f32 v58, v15, v58
    v_mul_f32 v59, v15, v59
    v_mul_f32 v74, v80, v74
    v_mul_f32 v75, v80, v75
    v_cvt_pk_bf16_f32 v81, v58, v59
    v_lshlrev_b32 v58, 16, v81
    v_and_b32 v59, 0xffff0000, v81
    v_cvt_pk_bf16_f32 v81, v74, v75
    v_lshlrev_b32 v74, 16, v81
    v_and_b32 v75, 0xffff0000, v81
    v_add_f32 v58, v58, v74
    v_add_f32 v59, v59, v75
    v_cvt_pk_bf16_f32 v89, v58, v59
    v_cvt_pk_bf16_f32 v81, v60, v61
    v_lshlrev_b32 v60, 16, v81
    v_and_b32 v61, 0xffff0000, v81
    v_cvt_pk_bf16_f32 v81, v76, v77
    v_lshlrev_b32 v76, 16, v81
    v_and_b32 v77, 0xffff0000, v81
    v_mul_f32 v60, v15, v60
    v_mul_f32 v61, v15, v61
    v_mul_f32 v76, v80, v76
    v_mul_f32 v77, v80, v77
    v_cvt_pk_bf16_f32 v81, v60, v61
    v_lshlrev_b32 v60, 16, v81
    v_and_b32 v61, 0xffff0000, v81
    v_cvt_pk_bf16_f32 v81, v76, v77
    v_lshlrev_b32 v76, 16, v81
    v_and_b32 v77, 0xffff0000, v81
    v_add_f32 v60, v60, v76
    v_add_f32 v61, v61, v77
    v_cvt_pk_bf16_f32 v90, v60, v61
    v_cvt_pk_bf16_f32 v81, v62, v63
    v_lshlrev_b32 v62, 16, v81
    v_and_b32 v63, 0xffff0000, v81
    v_cvt_pk_bf16_f32 v81, v78, v79
    v_lshlrev_b32 v78, 16, v81
    v_and_b32 v79, 0xffff0000, v81
    v_mul_f32 v62, v15, v62
    v_mul_f32 v63, v15, v63
    v_mul_f32 v78, v80, v78
    v_mul_f32 v79, v80, v79
    v_cvt_pk_bf16_f32 v81, v62, v63
    v_lshlrev_b32 v62, 16, v81
    v_and_b32 v63, 0xffff0000, v81
    v_cvt_pk_bf16_f32 v81, v78, v79
    v_lshlrev_b32 v78, 16, v81
    v_and_b32 v79, 0xffff0000, v81
    v_add_f32 v62, v62, v78
    v_add_f32 v63, v63, v79
    v_cvt_pk_bf16_f32 v91, v62, v63
    v_and_b32 v2, 31, v1
    v_lshrrev_b32 v3, 5, v1
    v_lshlrev_b32 v2, 10, v2
    v_lshl_add_u32 v2, v3, 3, v2
    s_lshl_b32 s43, s47, 10
    s_lshl_b32 s44, s42, 7
    s_add_u32 s43, s43, s44
    s_lshr_b32 s44, s49, 1
    s_lshl_b32 s44, s44, 6
    s_add_u32 s43, s43, s44
    buffer_store_dwordx2 v[84:85], v2, s[32:35], s43 offen offset:0
    buffer_store_dwordx2 v[86:87], v2, s[32:35], s43 offen offset:16
    buffer_store_dwordx2 v[88:89], v2, s[32:35], s43 offen offset:32
    buffer_store_dwordx2 v[90:91], v2, s[32:35], s43 offen offset:48
K3_END:
    s_endpgm
.section .rodata,"a"
.p2align 6
.amdhsa_kernel k1_proj_kernel
  .amdhsa_next_free_vgpr 128
  .amdhsa_next_free_sgpr 102
  .amdhsa_accum_offset 128
  .amdhsa_group_segment_fixed_size 0
  .amdhsa_kernarg_size 88
  .amdhsa_user_sgpr_count 2
  .amdhsa_user_sgpr_kernarg_segment_ptr 1
  .amdhsa_system_sgpr_workgroup_id_x 1
.end_amdhsa_kernel
.p2align 6
.amdhsa_kernel k2_attn_kernel
  .amdhsa_next_free_vgpr 128
  .amdhsa_next_free_sgpr 102
  .amdhsa_accum_offset 128
  .amdhsa_group_segment_fixed_size 0
  .amdhsa_kernarg_size 88
  .amdhsa_user_sgpr_count 2
  .amdhsa_user_sgpr_kernarg_segment_ptr 1
  .amdhsa_system_sgpr_workgroup_id_x 1
.end_amdhsa_kernel
.p2align 6
.amdhsa_kernel k3_out_kernel
  .amdhsa_next_free_vgpr 128
  .amdhsa_next_free_sgpr 102
  .amdhsa_accum_offset 128
  .amdhsa_group_segment_fixed_size 0
  .amdhsa_kernarg_size 88
  .amdhsa_user_sgpr_count 2
  .amdhsa_user_sgpr_kernarg_segment_ptr 1
  .amdhsa_system_sgpr_workgroup_id_x 1
.end_amdhsa_kernel
```
